```python
import torch

def _softmax(x, axis=-1):
    return torch.softmax(x, dim=axis)
def _gelu(x):
    return torch.nn.functional.gelu(x, approximate="tanh")
def _silu(x):
    return torch.nn.functional.silu(x)
def _sigmoid(x):
    return torch.sigmoid(x)
def _layernorm(x, axis=-1, eps=1e-5):
    m = x.mean(dim=axis, keepdim=True)
    v = x.var(dim=axis, keepdim=True, unbiased=False)
    return (x - m) / torch.sqrt(v + eps)
def _scatter_add(tgt, idx, src, axis=0):
    return tgt.clone().index_add_(axis, idx, src)
def _segment_sum(src, seg, n):
    out = torch.zeros((n,) + src.shape[1:], dtype=src.dtype)
    return out.index_add_(0, seg, src)
def _pad(x, pw):
    flat = tuple(v for pair in reversed(pw) for v in pair)
    return torch.nn.functional.pad(x, flat)

kernel_name = 'concat_heads__mha_block_cached__mha_block_cached__near_ridge'

def setup_inputs():

    _w = (lambda a: (lambda t: t.to(torch.bfloat16) if t.is_floating_point() else t)(torch.as_tensor(a)))
    def _A_setup():
        B, Sq, D = 8, 192, 512
        H, Sk, Dh = 32, 512, 128
        return {
            "x": _w((lambda *s: torch.randn(*s, dtype=torch.bfloat16) * 0.8)(B, Sq, D)),
            "k_cache": _w((lambda *s: torch.randn(*s, dtype=torch.bfloat16) * 0.8)(B, H, Sk, Dh)),
            "v_cache": _w((lambda *s: torch.randn(*s, dtype=torch.bfloat16) * 0.05)(B, H, Sk, Dh)),
            "wq": _w((lambda *s: torch.randn(*s, dtype=torch.bfloat16) * 0.8)(D, H * Dh) * (D ** -0.5)),
            "wo": _w((lambda *s: torch.randn(*s, dtype=torch.bfloat16) * 0.05)(H * Dh, D) * ((H * Dh) ** -0.5)),
        }
    _A_in = _A_setup()

    def _B_setup():
        B, Sq, D = 8, 192, 512
        H, Sk, Dh = 32, 512, 128
        return {
            "x": _w((lambda *s: torch.randn(*s, dtype=torch.bfloat16) * 0.8)(B, Sq, D)),
            "k_cache": _w((lambda *s: torch.randn(*s, dtype=torch.bfloat16) * 0.8)(B, H, Sk, Dh)),
            "v_cache": _w((lambda *s: torch.randn(*s, dtype=torch.bfloat16) * 0.05)(B, H, Sk, Dh)),
            "wq": _w((lambda *s: torch.randn(*s, dtype=torch.bfloat16) * 0.8)(D, H * Dh) * (D ** -0.5)),
            "wo": _w((lambda *s: torch.randn(*s, dtype=torch.bfloat16) * 0.05)(H * Dh, D) * ((H * Dh) ** -0.5)),
        }
    _B_in = _B_setup()

    return {
        "A_x": _A_in["x"],
        "A_k_cache": _A_in["k_cache"],
        "A_v_cache": _A_in["v_cache"],
        "A_wq": _A_in["wq"],
        "A_wo": _A_in["wo"],
        "B_x": _B_in["x"],
        "B_k_cache": _B_in["k_cache"],
        "B_v_cache": _B_in["v_cache"],
        "B_wq": _B_in["wq"],
        "B_wo": _B_in["wo"],
    }

def reference(A_x, A_k_cache, A_v_cache, A_wq, A_wo, B_x, B_k_cache, B_v_cache, B_wq, B_wo):
    def _A_ref(x, k_cache, v_cache, wq, wo):
        B, Sq, D = x.shape
        H, Dh = 32, 128
        q = (lambda x, *d: x.permute(*d))((x @ wq).reshape(B, Sq, H, Dh), 0, 2, 1, 3)
        scores = torch.einsum("bhqd,bhkd->bhqk", q, k_cache) * (Dh ** -0.5)
        p = _softmax(scores, axis=-1)
        o = torch.einsum("bhqk,bhkd->bhqd", p, v_cache)
        return (lambda x, *d: x.permute(*d))(o, 0, 2, 1, 3).reshape(B, Sq, H * Dh) @ wo

    def _B_ref(x, k_cache, v_cache, wq, wo):
        B, Sq, D = x.shape
        H, Dh = 32, 128
        q = (lambda x, *d: x.permute(*d))((x @ wq).reshape(B, Sq, H, Dh), 0, 2, 1, 3)
        scores = torch.einsum("bhqd,bhkd->bhqk", q, k_cache) * (Dh ** -0.5)
        p = _softmax(scores, axis=-1)
        o = torch.einsum("bhqk,bhkd->bhqd", p, v_cache)
        return (lambda x, *d: x.permute(*d))(o, 0, 2, 1, 3).reshape(B, Sq, H * Dh) @ wo

    a = _A_ref(A_x, A_k_cache, A_v_cache, A_wq, A_wo)
    b = _B_ref(B_x, B_k_cache, B_v_cache, B_wq, B_wo)
    return torch.concatenate([a, b], axis=-1)
```

```asm
; @launch kernel=concat_heads__mha_block_cached__mha_block_cached__near_ridge_kernel grid=(256,1,1) block=(512,1,1) lds=163840
; @launch kernel=oproj_kernel grid=(256,1,1) block=(512,1,1) lds=131072
; @launch kernel=reduce_kernel grid=(768,1,1) block=(256,1,1) lds=0
.amdgcn_target "amdgcn-amd-amdhsa--gfx950"
.text
.globl concat_heads__mha_block_cached__mha_block_cached__near_ridge_kernel
.p2align 8
.type concat_heads__mha_block_cached__mha_block_cached__near_ridge_kernel,@function
concat_heads__mha_block_cached__mha_block_cached__near_ridge_kernel:
s_cmp_ge_u32 s2, 256
s_cbranch_scc1 K1_END
v_mov_b32 v255, v0
v_lshrrev_b32 v1, 6, v0
s_nop 0
v_readfirstlane_b32 s28, v1
s_nop 0
s_lshr_b32 s29, s28, 2
s_and_b32 s30, s28, 3
s_and_b32 s3, s2, 7
s_lshr_b32 s4, s3, 2
s_and_b32 s5, s3, 3
s_lshr_b32 s6, s2, 3
s_and_b32 s7, s6, 7
s_lshr_b32 s6, s6, 3
s_lshl_b32 s5, s5, 2
s_add_u32 s5, s5, s6
s_lshl_b32 s5, s5, 1
s_add_u32 s5, s5, s29
s_mul_i32 s6, s4, 40
s_add_u32 s52, s0, s6
s_addc_u32 s53, s1, 0
s_load_dwordx4 s[56:59], s[52:53], 0
s_load_dwordx4 s[60:63], s[52:53], 16
s_load_dwordx2 s[64:65], s[0:1], 96
s_lshl_b32 s6, s7, 5
s_add_u32 s6, s6, s5
s_waitcnt lgkmcnt(0)
s_lshr_b32 s54, s6, 15
s_lshl_b32 s55, s6, 17
s_add_u32 s8, s58, s55
s_addc_u32 s9, s59, s54
s_mov_b32 s10, 131072
s_mov_b32 s11, 0x20000
s_add_u32 s12, s60, s55
s_addc_u32 s13, s61, s54
s_mov_b32 s14, 131072
s_mov_b32 s15, 0x20000
s_lshl_b32 s54, s5, 8
s_add_u32 s16, s62, s54
s_addc_u32 s17, s63, 0
s_sub_u32 s18, 0x400000, s54
s_mov_b32 s19, 0x20000
s_mul_i32 s54, s7, 196608
s_add_u32 s20, s56, s54
s_addc_u32 s21, s57, 0
s_mov_b32 s22, 196608
s_mov_b32 s23, 0x20000
s_lshl_b32 s54, s4, 8
s_add_u32 s54, s54, s6
s_mul_i32 s54, s54, 49152
s_add_u32 s24, s64, s54
s_addc_u32 s25, s65, 0
s_mov_b32 s26, 49152
s_mov_b32 s27, 0x20000
s_mul_i32 s36, s30, 12288
s_mov_b32 s37, 0x47800000
s_mov_b32 s66, 107520
s_mov_b32 s67, 0xffff7400
s_mov_b32 s68, 89088
s_mov_b32 s69, 0xffff8c00
s_mov_b32 s70, 0x78
v_and_b32 v1, 63, v0
v_lshrrev_b32 v2, 4, v1
v_and_b32 v3, 15, v1
s_lshl_b32 s54, s30, 2
v_add_u32 v4, s54, v2
v_xor_b32 v5, v3, v2
v_lshlrev_b32 v5, 4, v5
v_lshl_add_u32 v235, v4, 8, v5
v_lshlrev_b32 v5, 1, v2
v_xor_b32 v5, v3, v5
v_lshlrev_b32 v5, 4, v5
v_lshl_add_u32 v236, v4, 8, v5
v_lshl_add_u32 v242, v4, 13, v5
v_lshlrev_b32 v5, 1, v2
v_lshrrev_b32 v5, v5, s70
v_and_b32 v5, 3, v5
v_and_b32 v6, 3, v1
v_xor_b32 v6, v6, v5
v_lshlrev_b32 v6, 4, v6
v_lshrrev_b32 v7, 2, v1
v_lshl_add_u32 v243, v7, 10, v6
v_lshrrev_b32 v4, 2, v3
v_and_b32 v5, 3, v3
v_mul_u32_u24 v6, 1088, v4
v_lshl_add_u32 v6, v5, 8, v6
v_xor_b32 v7, v2, v5
v_lshl_add_u32 v6, v7, 4, v6
s_mul_i32 s54, s29, 17920
s_add_u32 s54, s54, 128000
v_add_u32 v230, s54, v6
v_lshrrev_b32 v6, 1, v5
v_and_b32 v7, 1, v5
v_lshlrev_b32 v7, 3, v7
v_lshl_add_u32 v7, v6, 4, v7
v_lshl_add_u32 v7, v4, 8, v7
v_mul_u32_u24 v8, 1152, v2
s_add_u32 s55, s54, 8704
v_add_u32 v8, s55, v8
v_mul_u32_u24 v9, 2176, v2
s_mul_i32 s55, s29, 8704
s_add_u32 s55, s55, 101376
v_add_u32 v9, s55, v9
v_xor_b32 v10, 0, v4
v_lshl_add_u32 v10, v10, 5, v7
v_add_u32 v231, v8, v10
v_add_u32 v237, v9, v10
v_xor_b32 v10, 1, v4
v_lshl_add_u32 v10, v10, 5, v7
v_add_u32 v232, v8, v10
v_add_u32 v238, v9, v10
v_xor_b32 v10, 2, v4
v_lshl_add_u32 v10, v10, 5, v7
v_add_u32 v233, v8, v10
v_add_u32 v239, v9, v10
v_xor_b32 v10, 3, v4
v_lshl_add_u32 v10, v10, 5, v7
v_add_u32 v234, v8, v10
v_add_u32 v240, v9, v10
v_lshlrev_b32 v6, 1, v4
v_lshrrev_b32 v6, v6, s70
v_and_b32 v6, 3, v6
v_xor_b32 v6, v6, v2
v_lshlrev_b32 v6, 4, v6
v_lshl_add_u32 v6, v3, 6, v6
s_mul_i32 s55, s30, 3072
s_add_u32 s55, s55, 89088
v_add_u32 v241, s55, v6
s_mov_b32 s32, 0
s_mov_b32 s33, 0
s_mul_i32 s55, s30, 1088
s_add_u32 s34, s54, s55
s_mul_i32 s55, s30, 1152
s_add_u32 s35, s54, s55
s_add_u32 s35, s35, 8704
s_mov_b32 s48, 0
s_mov_b32 s49, 0
s_mov_b32 s50, 0
s_mov_b32 s51, 0
s_mul_i32 s55, s30, 1088
s_add_u32 s42, s55, 89088
s_mov_b32 s43, 0
s_lshl_b32 s55, s28, 10
s_add_u32 s44, s55, 89088
s_lshl_b32 s45, s28, 14
s_mov_b32 s46, 0
s_mov_b32 s47, 0
s_cmp_eq_u32 s29, 1
s_cbranch_scc1 START_R1
s_add_u32 m0, s42, 12288
s_nop 0
buffer_load_dwordx4 v242, s[16:19], s43 offen lds
s_add_u32 m0, s42, 16640
s_add_u32 s38, s43, 131072
buffer_load_dwordx4 v242, s[16:19], s38 offen lds
s_mov_b32 m0, s44
s_nop 0
buffer_load_dwordx4 v243, s[20:23], s45 offen lds
s_add_u32 m0, s44, 8192
s_add_u32 s38, s45, 131072
buffer_load_dwordx4 v243, s[20:23], s38 offen lds
s_add_u32 s43, s43, 262144
s_add_u32 s45, s45, 64
s_add_u32 s46, s46, 1
s_and_b32 s46, s46, 3
s_cmp_eq_u32 s46, 0
s_cselect_b32 s38, s68, s69
s_add_u32 s42, s42, s38
s_add_u32 s44, s44, s38
s_add_u32 m0, s42, 12288
s_nop 0
buffer_load_dwordx4 v242, s[16:19], s43 offen lds
s_add_u32 m0, s42, 16640
s_add_u32 s38, s43, 131072
buffer_load_dwordx4 v242, s[16:19], s38 offen lds
s_mov_b32 m0, s44
s_nop 0
buffer_load_dwordx4 v243, s[20:23], s45 offen lds
s_add_u32 m0, s44, 8192
s_add_u32 s38, s45, 131072
buffer_load_dwordx4 v243, s[20:23], s38 offen lds
s_add_u32 s43, s43, 262144
s_add_u32 s45, s45, 64
s_add_u32 s46, s46, 1
s_and_b32 s46, s46, 3
s_cmp_eq_u32 s46, 0
s_cselect_b32 s38, s68, s69
s_add_u32 s42, s42, s38
s_add_u32 s44, s44, s38
s_add_u32 m0, s42, 12288
s_nop 0
buffer_load_dwordx4 v242, s[16:19], s43 offen lds
s_add_u32 m0, s42, 16640
s_add_u32 s38, s43, 131072
buffer_load_dwordx4 v242, s[16:19], s38 offen lds
s_mov_b32 m0, s44
s_nop 0
buffer_load_dwordx4 v243, s[20:23], s45 offen lds
s_add_u32 m0, s44, 8192
s_add_u32 s38, s45, 131072
buffer_load_dwordx4 v243, s[20:23], s38 offen lds
s_add_u32 s43, s43, 262144
s_add_u32 s45, s45, 64
s_add_u32 s46, s46, 1
s_and_b32 s46, s46, 3
s_cmp_eq_u32 s46, 0
s_cselect_b32 s38, s68, s69
s_add_u32 s42, s42, s38
s_add_u32 s44, s44, s38
v_mov_b32 v0, 0
v_mov_b32 v1, 0
v_mov_b32 v2, 0
v_mov_b32 v3, 0
v_mov_b32 v4, 0
v_mov_b32 v5, 0
v_mov_b32 v6, 0
v_mov_b32 v7, 0
v_mov_b32 v8, 0
v_mov_b32 v9, 0
v_mov_b32 v10, 0
v_mov_b32 v11, 0
v_mov_b32 v12, 0
v_mov_b32 v13, 0
v_mov_b32 v14, 0
v_mov_b32 v15, 0
v_mov_b32 v16, 0
v_mov_b32 v17, 0
v_mov_b32 v18, 0
v_mov_b32 v19, 0
v_mov_b32 v20, 0
v_mov_b32 v21, 0
v_mov_b32 v22, 0
v_mov_b32 v23, 0
v_mov_b32 v24, 0
v_mov_b32 v25, 0
v_mov_b32 v26, 0
v_mov_b32 v27, 0
v_mov_b32 v28, 0
v_mov_b32 v29, 0
v_mov_b32 v30, 0
v_mov_b32 v31, 0
v_mov_b32 v32, 0
v_mov_b32 v33, 0
v_mov_b32 v34, 0
v_mov_b32 v35, 0
v_mov_b32 v36, 0
v_mov_b32 v37, 0
v_mov_b32 v38, 0
v_mov_b32 v39, 0
v_mov_b32 v40, 0
v_mov_b32 v41, 0
v_mov_b32 v42, 0
v_mov_b32 v43, 0
v_mov_b32 v44, 0
v_mov_b32 v45, 0
v_mov_b32 v46, 0
v_mov_b32 v47, 0
v_mov_b32 v48, 0
v_mov_b32 v49, 0
v_mov_b32 v50, 0
v_mov_b32 v51, 0
v_mov_b32 v52, 0
v_mov_b32 v53, 0
v_mov_b32 v54, 0
v_mov_b32 v55, 0
v_mov_b32 v56, 0
v_mov_b32 v57, 0
v_mov_b32 v58, 0
v_mov_b32 v59, 0
v_mov_b32 v60, 0
v_mov_b32 v61, 0
v_mov_b32 v62, 0
v_mov_b32 v63, 0
v_mov_b32 v64, 0
v_mov_b32 v65, 0
v_mov_b32 v66, 0
v_mov_b32 v67, 0
v_mov_b32 v68, 0
v_mov_b32 v69, 0
v_mov_b32 v70, 0
v_mov_b32 v71, 0
v_mov_b32 v72, 0
v_mov_b32 v73, 0
v_mov_b32 v74, 0
v_mov_b32 v75, 0
v_mov_b32 v76, 0
v_mov_b32 v77, 0
v_mov_b32 v78, 0
v_mov_b32 v79, 0
v_mov_b32 v80, 0
v_mov_b32 v81, 0
v_mov_b32 v82, 0
v_mov_b32 v83, 0
v_mov_b32 v84, 0
v_mov_b32 v85, 0
v_mov_b32 v86, 0
v_mov_b32 v87, 0
v_mov_b32 v88, 0
v_mov_b32 v89, 0
v_mov_b32 v90, 0
v_mov_b32 v91, 0
v_mov_b32 v92, 0
v_mov_b32 v93, 0
v_mov_b32 v94, 0
v_mov_b32 v95, 0
s_waitcnt vmcnt(8)
s_barrier
ds_read_b128 v[144:147], v241 offset:0
ds_read_b64_tr_b16 v[180:181], v237 offset:0
ds_read_b64_tr_b16 v[182:183], v237 offset:1088
ds_read_b128 v[148:151], v241 offset:1024
ds_read_b128 v[152:155], v241 offset:2048
ds_read_b64_tr_b16 v[184:185], v238 offset:0
ds_read_b64_tr_b16 v[186:187], v238 offset:1088
ds_read_b64_tr_b16 v[188:189], v239 offset:0
ds_read_b64_tr_b16 v[190:191], v239 offset:1088
s_add_u32 m0, s42, 12288
s_nop 0
buffer_load_dwordx4 v242, s[16:19], s43 offen lds
ds_read_b64_tr_b16 v[192:193], v240 offset:0
ds_read_b64_tr_b16 v[194:195], v240 offset:1088
ds_read_b64_tr_b16 v[196:197], v237 offset:128
ds_read_b64_tr_b16 v[198:199], v237 offset:1216
s_add_u32 m0, s42, 16640
s_add_u32 s38, s43, 131072
buffer_load_dwordx4 v242, s[16:19], s38 offen lds
s_add_u32 s47, s47, 1
s_and_b32 s47, s47, 3
s_cmp_eq_u32 s47, 0
s_cselect_b32 s39, s68, s69
s_waitcnt lgkmcnt(10)
v_mfma_f32_16x16x32_bf16 v[0:3], v[180:183], v[144:147], v[0:3]
s_waitcnt lgkmcnt(9)
v_mfma_f32_16x16x32_bf16 v[4:7], v[180:183], v[148:151], v[4:7]
s_waitcnt lgkmcnt(8)
v_mfma_f32_16x16x32_bf16 v[8:11], v[180:183], v[152:155], v[8:11]
ds_read_b64_tr_b16 v[200:201], v238 offset:128
ds_read_b64_tr_b16 v[202:203], v238 offset:1216
s_waitcnt lgkmcnt(8)
v_mfma_f32_16x16x32_bf16 v[12:15], v[184:187], v[144:147], v[12:15]
v_mfma_f32_16x16x32_bf16 v[16:19], v[184:187], v[148:151], v[16:19]
v_mfma_f32_16x16x32_bf16 v[20:23], v[184:187], v[152:155], v[20:23]
ds_read_b64_tr_b16 v[204:205], v239 offset:128
ds_read_b64_tr_b16 v[206:207], v239 offset:1216
s_mov_b32 m0, s44
s_nop 0
buffer_load_dwordx4 v243, s[20:23], s45 offen lds
s_waitcnt lgkmcnt(8)
v_mfma_f32_16x16x32_bf16 v[24:27], v[188:191], v[144:147], v[24:27]
v_mfma_f32_16x16x32_bf16 v[28:31], v[188:191], v[148:151], v[28:31]
v_mfma_f32_16x16x32_bf16 v[32:35], v[188:191], v[152:155], v[32:35]
ds_read_b64_tr_b16 v[208:209], v240 offset:128
ds_read_b64_tr_b16 v[210:211], v240 offset:1216
s_waitcnt lgkmcnt(8)
v_mfma_f32_16x16x32_bf16 v[36:39], v[192:195], v[144:147], v[36:39]
v_mfma_f32_16x16x32_bf16 v[40:43], v[192:195], v[148:151], v[40:43]
v_mfma_f32_16x16x32_bf16 v[44:47], v[192:195], v[152:155], v[44:47]
v_add_u32 v241, s39, v241
v_add_u32 v237, s39, v237
v_add_u32 v238, s39, v238
v_add_u32 v239, s39, v239
v_add_u32 v240, s39, v240
s_add_u32 m0, s44, 8192
s_add_u32 s38, s45, 131072
buffer_load_dwordx4 v243, s[20:23], s38 offen lds
s_add_u32 s43, s43, 262144
s_add_u32 s45, s45, 64
s_add_u32 s46, s46, 1
s_and_b32 s46, s46, 3
s_cmp_eq_u32 s46, 0
s_cselect_b32 s38, s68, s69
s_add_u32 s42, s42, s38
s_add_u32 s44, s44, s38
s_waitcnt lgkmcnt(6)
v_mfma_f32_16x16x32_bf16 v[48:51], v[196:199], v[144:147], v[48:51]
v_mfma_f32_16x16x32_bf16 v[52:55], v[196:199], v[148:151], v[52:55]
v_mfma_f32_16x16x32_bf16 v[56:59], v[196:199], v[152:155], v[56:59]
s_mov_b32 m0, s34
s_nop 0
buffer_load_dwordx4 v235, s[8:11], s32 offen nt lds
s_add_u32 m0, s34, 4352
s_add_u32 s38, s32, 4096
buffer_load_dwordx4 v235, s[8:11], s38 offen nt lds
s_add_u32 s32, s32, 8192
s_add_u32 s48, s48, 1
s_and_b32 s48, s48, 3
s_cmp_eq_u32 s48, 0
s_cselect_b32 s38, s66, s67
s_add_u32 s34, s34, s38
s_mov_b32 m0, s35
s_nop 0
buffer_load_dwordx4 v236, s[12:15], s33 offen nt lds
s_add_u32 m0, s35, 4608
s_add_u32 s38, s33, 4096
buffer_load_dwordx4 v236, s[12:15], s38 offen nt lds
s_add_u32 s33, s33, 8192
s_add_u32 s49, s49, 1
s_and_b32 s49, s49, 3
s_cmp_eq_u32 s49, 0
s_cselect_b32 s38, s66, s67
s_add_u32 s35, s35, s38
s_waitcnt lgkmcnt(0)
s_waitcnt vmcnt(12)
s_barrier
ds_read_b128 v[168:171], v241 offset:0
ds_read_b64_tr_b16 v[180:181], v237 offset:0
ds_read_b64_tr_b16 v[182:183], v237 offset:1088
ds_read_b128 v[172:175], v241 offset:1024
ds_read_b128 v[176:179], v241 offset:2048
ds_read_b64_tr_b16 v[184:185], v238 offset:0
ds_read_b64_tr_b16 v[186:187], v238 offset:1088
v_mfma_f32_16x16x32_bf16 v[60:63], v[200:203], v[144:147], v[60:63]
v_mfma_f32_16x16x32_bf16 v[64:67], v[200:203], v[148:151], v[64:67]
v_mfma_f32_16x16x32_bf16 v[68:71], v[200:203], v[152:155], v[68:71]
ds_read_b64_tr_b16 v[188:189], v239 offset:0
ds_read_b64_tr_b16 v[190:191], v239 offset:1088
s_add_u32 m0, s42, 12288
s_nop 0
buffer_load_dwordx4 v242, s[16:19], s43 offen lds
v_mfma_f32_16x16x32_bf16 v[72:75], v[204:207], v[144:147], v[72:75]
v_mfma_f32_16x16x32_bf16 v[76:79], v[204:207], v[148:151], v[76:79]
v_mfma_f32_16x16x32_bf16 v[80:83], v[204:207], v[152:155], v[80:83]
ds_read_b64_tr_b16 v[192:193], v240 offset:0
ds_read_b64_tr_b16 v[194:195], v240 offset:1088
v_mfma_f32_16x16x32_bf16 v[84:87], v[208:211], v[144:147], v[84:87]
v_mfma_f32_16x16x32_bf16 v[88:91], v[208:211], v[148:151], v[88:91]
v_mfma_f32_16x16x32_bf16 v[92:95], v[208:211], v[152:155], v[92:95]
ds_read_b64_tr_b16 v[196:197], v237 offset:128
ds_read_b64_tr_b16 v[198:199], v237 offset:1216
s_add_u32 m0, s42, 16640
s_add_u32 s38, s43, 131072
buffer_load_dwordx4 v242, s[16:19], s38 offen lds
s_add_u32 s47, s47, 1
s_and_b32 s47, s47, 3
s_cmp_eq_u32 s47, 0
s_cselect_b32 s39, s68, s69
s_waitcnt lgkmcnt(10)
v_mfma_f32_16x16x32_bf16 v[0:3], v[180:183], v[168:171], v[0:3]
s_waitcnt lgkmcnt(9)
v_mfma_f32_16x16x32_bf16 v[4:7], v[180:183], v[172:175], v[4:7]
s_waitcnt lgkmcnt(8)
v_mfma_f32_16x16x32_bf16 v[8:11], v[180:183], v[176:179], v[8:11]
ds_read_b64_tr_b16 v[200:201], v238 offset:128
ds_read_b64_tr_b16 v[202:203], v238 offset:1216
s_waitcnt lgkmcnt(8)
v_mfma_f32_16x16x32_bf16 v[12:15], v[184:187], v[168:171], v[12:15]
v_mfma_f32_16x16x32_bf16 v[16:19], v[184:187], v[172:175], v[16:19]
v_mfma_f32_16x16x32_bf16 v[20:23], v[184:187], v[176:179], v[20:23]
ds_read_b64_tr_b16 v[204:205], v239 offset:128
ds_read_b64_tr_b16 v[206:207], v239 offset:1216
s_mov_b32 m0, s44
s_nop 0
buffer_load_dwordx4 v243, s[20:23], s45 offen lds
s_waitcnt lgkmcnt(8)
v_mfma_f32_16x16x32_bf16 v[24:27], v[188:191], v[168:171], v[24:27]
v_mfma_f32_16x16x32_bf16 v[28:31], v[188:191], v[172:175], v[28:31]
v_mfma_f32_16x16x32_bf16 v[32:35], v[188:191], v[176:179], v[32:35]
ds_read_b64_tr_b16 v[208:209], v240 offset:128
ds_read_b64_tr_b16 v[210:211], v240 offset:1216
s_waitcnt lgkmcnt(8)
v_mfma_f32_16x16x32_bf16 v[36:39], v[192:195], v[168:171], v[36:39]
v_mfma_f32_16x16x32_bf16 v[40:43], v[192:195], v[172:175], v[40:43]
v_mfma_f32_16x16x32_bf16 v[44:47], v[192:195], v[176:179], v[44:47]
v_add_u32 v241, s39, v241
v_add_u32 v237, s39, v237
v_add_u32 v238, s39, v238
v_add_u32 v239, s39, v239
v_add_u32 v240, s39, v240
s_add_u32 m0, s44, 8192
s_add_u32 s38, s45, 131072
buffer_load_dwordx4 v243, s[20:23], s38 offen lds
s_add_u32 s43, s43, 262144
s_add_u32 s45, s45, 64
s_add_u32 s46, s46, 1
s_and_b32 s46, s46, 3
s_cmp_eq_u32 s46, 0
s_cselect_b32 s38, s68, s69
s_add_u32 s42, s42, s38
s_add_u32 s44, s44, s38
s_waitcnt lgkmcnt(6)
v_mfma_f32_16x16x32_bf16 v[48:51], v[196:199], v[168:171], v[48:51]
v_mfma_f32_16x16x32_bf16 v[52:55], v[196:199], v[172:175], v[52:55]
v_mfma_f32_16x16x32_bf16 v[56:59], v[196:199], v[176:179], v[56:59]
s_waitcnt lgkmcnt(0)
s_waitcnt vmcnt(12)
s_barrier
ds_read_b128 v[144:147], v241 offset:0
ds_read_b64_tr_b16 v[180:181], v237 offset:0
ds_read_b64_tr_b16 v[182:183], v237 offset:1088
ds_read_b128 v[148:151], v241 offset:1024
ds_read_b128 v[152:155], v241 offset:2048
ds_read_b64_tr_b16 v[184:185], v238 offset:0
ds_read_b64_tr_b16 v[186:187], v238 offset:1088
v_mfma_f32_16x16x32_bf16 v[60:63], v[200:203], v[168:171], v[60:63]
v_mfma_f32_16x16x32_bf16 v[64:67], v[200:203], v[172:175], v[64:67]
v_mfma_f32_16x16x32_bf16 v[68:71], v[200:203], v[176:179], v[68:71]
ds_read_b64_tr_b16 v[188:189], v239 offset:0
ds_read_b64_tr_b16 v[190:191], v239 offset:1088
s_add_u32 m0, s42, 12288
s_nop 0
buffer_load_dwordx4 v242, s[16:19], s43 offen lds
v_mfma_f32_16x16x32_bf16 v[72:75], v[204:207], v[168:171], v[72:75]
v_mfma_f32_16x16x32_bf16 v[76:79], v[204:207], v[172:175], v[76:79]
v_mfma_f32_16x16x32_bf16 v[80:83], v[204:207], v[176:179], v[80:83]
ds_read_b64_tr_b16 v[192:193], v240 offset:0
ds_read_b64_tr_b16 v[194:195], v240 offset:1088
v_mfma_f32_16x16x32_bf16 v[84:87], v[208:211], v[168:171], v[84:87]
v_mfma_f32_16x16x32_bf16 v[88:91], v[208:211], v[172:175], v[88:91]
v_mfma_f32_16x16x32_bf16 v[92:95], v[208:211], v[176:179], v[92:95]
ds_read_b64_tr_b16 v[196:197], v237 offset:128
ds_read_b64_tr_b16 v[198:199], v237 offset:1216
s_add_u32 m0, s42, 16640
s_add_u32 s38, s43, 131072
buffer_load_dwordx4 v242, s[16:19], s38 offen lds
s_add_u32 s47, s47, 1
s_and_b32 s47, s47, 3
s_cmp_eq_u32 s47, 0
s_cselect_b32 s39, s68, s69
s_waitcnt lgkmcnt(10)
v_mfma_f32_16x16x32_bf16 v[0:3], v[180:183], v[144:147], v[0:3]
s_waitcnt lgkmcnt(9)
v_mfma_f32_16x16x32_bf16 v[4:7], v[180:183], v[148:151], v[4:7]
s_waitcnt lgkmcnt(8)
v_mfma_f32_16x16x32_bf16 v[8:11], v[180:183], v[152:155], v[8:11]
ds_read_b64_tr_b16 v[200:201], v238 offset:128
ds_read_b64_tr_b16 v[202:203], v238 offset:1216
s_waitcnt lgkmcnt(8)
v_mfma_f32_16x16x32_bf16 v[12:15], v[184:187], v[144:147], v[12:15]
v_mfma_f32_16x16x32_bf16 v[16:19], v[184:187], v[148:151], v[16:19]
v_mfma_f32_16x16x32_bf16 v[20:23], v[184:187], v[152:155], v[20:23]
ds_read_b64_tr_b16 v[204:205], v239 offset:128
ds_read_b64_tr_b16 v[206:207], v239 offset:1216
s_mov_b32 m0, s44
s_nop 0
buffer_load_dwordx4 v243, s[20:23], s45 offen lds
s_waitcnt lgkmcnt(8)
v_mfma_f32_16x16x32_bf16 v[24:27], v[188:191], v[144:147], v[24:27]
v_mfma_f32_16x16x32_bf16 v[28:31], v[188:191], v[148:151], v[28:31]
v_mfma_f32_16x16x32_bf16 v[32:35], v[188:191], v[152:155], v[32:35]
ds_read_b64_tr_b16 v[208:209], v240 offset:128
ds_read_b64_tr_b16 v[210:211], v240 offset:1216
s_waitcnt lgkmcnt(8)
v_mfma_f32_16x16x32_bf16 v[36:39], v[192:195], v[144:147], v[36:39]
v_mfma_f32_16x16x32_bf16 v[40:43], v[192:195], v[148:151], v[40:43]
v_mfma_f32_16x16x32_bf16 v[44:47], v[192:195], v[152:155], v[44:47]
v_add_u32 v241, s39, v241
v_add_u32 v237, s39, v237
v_add_u32 v238, s39, v238
v_add_u32 v239, s39, v239
v_add_u32 v240, s39, v240
s_add_u32 m0, s44, 8192
s_add_u32 s38, s45, 131072
buffer_load_dwordx4 v243, s[20:23], s38 offen lds
s_add_u32 s43, s43, 262144
s_add_u32 s45, s45, 64
s_add_u32 s46, s46, 1
s_and_b32 s46, s46, 3
s_cmp_eq_u32 s46, 0
s_cselect_b32 s38, s68, s69
s_add_u32 s42, s42, s38
s_add_u32 s44, s44, s38
s_waitcnt lgkmcnt(6)
v_mfma_f32_16x16x32_bf16 v[48:51], v[196:199], v[144:147], v[48:51]
v_mfma_f32_16x16x32_bf16 v[52:55], v[196:199], v[148:151], v[52:55]
v_mfma_f32_16x16x32_bf16 v[56:59], v[196:199], v[152:155], v[56:59]
s_waitcnt lgkmcnt(0)
s_waitcnt vmcnt(12)
s_barrier
s_mov_b32 s31, 3
QL_R0:
ds_read_b128 v[168:171], v241 offset:0
ds_read_b64_tr_b16 v[180:181], v237 offset:0
ds_read_b64_tr_b16 v[182:183], v237 offset:1088
ds_read_b128 v[172:175], v241 offset:1024
ds_read_b128 v[176:179], v241 offset:2048
ds_read_b64_tr_b16 v[184:185], v238 offset:0
ds_read_b64_tr_b16 v[186:187], v238 offset:1088
v_mfma_f32_16x16x32_bf16 v[60:63], v[200:203], v[144:147], v[60:63]
v_mfma_f32_16x16x32_bf16 v[64:67], v[200:203], v[148:151], v[64:67]
v_mfma_f32_16x16x32_bf16 v[68:71], v[200:203], v[152:155], v[68:71]
ds_read_b64_tr_b16 v[188:189], v239 offset:0
ds_read_b64_tr_b16 v[190:191], v239 offset:1088
s_add_u32 m0, s42, 12288
s_nop 0
buffer_load_dwordx4 v242, s[16:19], s43 offen lds
v_mfma_f32_16x16x32_bf16 v[72:75], v[204:207], v[144:147], v[72:75]
v_mfma_f32_16x16x32_bf16 v[76:79], v[204:207], v[148:151], v[76:79]
v_mfma_f32_16x16x32_bf16 v[80:83], v[204:207], v[152:155], v[80:83]
ds_read_b64_tr_b16 v[192:193], v240 offset:0
ds_read_b64_tr_b16 v[194:195], v240 offset:1088
v_mfma_f32_16x16x32_bf16 v[84:87], v[208:211], v[144:147], v[84:87]
v_mfma_f32_16x16x32_bf16 v[88:91], v[208:211], v[148:151], v[88:91]
v_mfma_f32_16x16x32_bf16 v[92:95], v[208:211], v[152:155], v[92:95]
ds_read_b64_tr_b16 v[196:197], v237 offset:128
ds_read_b64_tr_b16 v[198:199], v237 offset:1216
s_add_u32 m0, s42, 16640
s_add_u32 s38, s43, 131072
buffer_load_dwordx4 v242, s[16:19], s38 offen lds
s_add_u32 s47, s47, 1
s_and_b32 s47, s47, 3
s_cmp_eq_u32 s47, 0
s_cselect_b32 s39, s68, s69
s_waitcnt lgkmcnt(10)
v_mfma_f32_16x16x32_bf16 v[0:3], v[180:183], v[168:171], v[0:3]
s_waitcnt lgkmcnt(9)
v_mfma_f32_16x16x32_bf16 v[4:7], v[180:183], v[172:175], v[4:7]
s_waitcnt lgkmcnt(8)
v_mfma_f32_16x16x32_bf16 v[8:11], v[180:183], v[176:179], v[8:11]
ds_read_b64_tr_b16 v[200:201], v238 offset:128
ds_read_b64_tr_b16 v[202:203], v238 offset:1216
s_waitcnt lgkmcnt(8)
v_mfma_f32_16x16x32_bf16 v[12:15], v[184:187], v[168:171], v[12:15]
v_mfma_f32_16x16x32_bf16 v[16:19], v[184:187], v[172:175], v[16:19]
v_mfma_f32_16x16x32_bf16 v[20:23], v[184:187], v[176:179], v[20:23]
ds_read_b64_tr_b16 v[204:205], v239 offset:128
ds_read_b64_tr_b16 v[206:207], v239 offset:1216
s_mov_b32 m0, s44
s_nop 0
buffer_load_dwordx4 v243, s[20:23], s45 offen lds
s_waitcnt lgkmcnt(8)
v_mfma_f32_16x16x32_bf16 v[24:27], v[188:191], v[168:171], v[24:27]
v_mfma_f32_16x16x32_bf16 v[28:31], v[188:191], v[172:175], v[28:31]
v_mfma_f32_16x16x32_bf16 v[32:35], v[188:191], v[176:179], v[32:35]
ds_read_b64_tr_b16 v[208:209], v240 offset:128
ds_read_b64_tr_b16 v[210:211], v240 offset:1216
s_waitcnt lgkmcnt(8)
v_mfma_f32_16x16x32_bf16 v[36:39], v[192:195], v[168:171], v[36:39]
v_mfma_f32_16x16x32_bf16 v[40:43], v[192:195], v[172:175], v[40:43]
v_mfma_f32_16x16x32_bf16 v[44:47], v[192:195], v[176:179], v[44:47]
v_add_u32 v241, s39, v241
v_add_u32 v237, s39, v237
v_add_u32 v238, s39, v238
v_add_u32 v239, s39, v239
v_add_u32 v240, s39, v240
s_add_u32 m0, s44, 8192
s_add_u32 s38, s45, 131072
buffer_load_dwordx4 v243, s[20:23], s38 offen lds
s_add_u32 s43, s43, 262144
s_add_u32 s45, s45, 64
s_add_u32 s46, s46, 1
s_and_b32 s46, s46, 3
s_cmp_eq_u32 s46, 0
s_cselect_b32 s38, s68, s69
s_add_u32 s42, s42, s38
s_add_u32 s44, s44, s38
s_waitcnt lgkmcnt(6)
v_mfma_f32_16x16x32_bf16 v[48:51], v[196:199], v[168:171], v[48:51]
v_mfma_f32_16x16x32_bf16 v[52:55], v[196:199], v[172:175], v[52:55]
v_mfma_f32_16x16x32_bf16 v[56:59], v[196:199], v[176:179], v[56:59]
s_waitcnt lgkmcnt(0)
s_waitcnt vmcnt(8)
s_barrier
s_add_u32 s31, s31, 1
ds_read_b128 v[144:147], v241 offset:0
ds_read_b64_tr_b16 v[180:181], v237 offset:0
ds_read_b64_tr_b16 v[182:183], v237 offset:1088
ds_read_b128 v[148:151], v241 offset:1024
ds_read_b128 v[152:155], v241 offset:2048
ds_read_b64_tr_b16 v[184:185], v238 offset:0
ds_read_b64_tr_b16 v[186:187], v238 offset:1088
v_mfma_f32_16x16x32_bf16 v[60:63], v[200:203], v[168:171], v[60:63]
v_mfma_f32_16x16x32_bf16 v[64:67], v[200:203], v[172:175], v[64:67]
v_mfma_f32_16x16x32_bf16 v[68:71], v[200:203], v[176:179], v[68:71]
ds_read_b64_tr_b16 v[188:189], v239 offset:0
ds_read_b64_tr_b16 v[190:191], v239 offset:1088
s_add_u32 m0, s42, 12288
s_nop 0
buffer_load_dwordx4 v242, s[16:19], s43 offen lds
v_mfma_f32_16x16x32_bf16 v[72:75], v[204:207], v[168:171], v[72:75]
v_mfma_f32_16x16x32_bf16 v[76:79], v[204:207], v[172:175], v[76:79]
v_mfma_f32_16x16x32_bf16 v[80:83], v[204:207], v[176:179], v[80:83]
ds_read_b64_tr_b16 v[192:193], v240 offset:0
ds_read_b64_tr_b16 v[194:195], v240 offset:1088
v_mfma_f32_16x16x32_bf16 v[84:87], v[208:211], v[168:171], v[84:87]
v_mfma_f32_16x16x32_bf16 v[88:91], v[208:211], v[172:175], v[88:91]
v_mfma_f32_16x16x32_bf16 v[92:95], v[208:211], v[176:179], v[92:95]
ds_read_b64_tr_b16 v[196:197], v237 offset:128
ds_read_b64_tr_b16 v[198:199], v237 offset:1216
s_add_u32 m0, s42, 16640
s_add_u32 s38, s43, 131072
buffer_load_dwordx4 v242, s[16:19], s38 offen lds
s_add_u32 s47, s47, 1
s_and_b32 s47, s47, 3
s_cmp_eq_u32 s47, 0
s_cselect_b32 s39, s68, s69
s_waitcnt lgkmcnt(10)
v_mfma_f32_16x16x32_bf16 v[0:3], v[180:183], v[144:147], v[0:3]
s_waitcnt lgkmcnt(9)
v_mfma_f32_16x16x32_bf16 v[4:7], v[180:183], v[148:151], v[4:7]
s_waitcnt lgkmcnt(8)
v_mfma_f32_16x16x32_bf16 v[8:11], v[180:183], v[152:155], v[8:11]
ds_read_b64_tr_b16 v[200:201], v238 offset:128
ds_read_b64_tr_b16 v[202:203], v238 offset:1216
s_waitcnt lgkmcnt(8)
v_mfma_f32_16x16x32_bf16 v[12:15], v[184:187], v[144:147], v[12:15]
v_mfma_f32_16x16x32_bf16 v[16:19], v[184:187], v[148:151], v[16:19]
v_mfma_f32_16x16x32_bf16 v[20:23], v[184:187], v[152:155], v[20:23]
ds_read_b64_tr_b16 v[204:205], v239 offset:128
ds_read_b64_tr_b16 v[206:207], v239 offset:1216
s_mov_b32 m0, s44
s_nop 0
buffer_load_dwordx4 v243, s[20:23], s45 offen lds
s_waitcnt lgkmcnt(8)
v_mfma_f32_16x16x32_bf16 v[24:27], v[188:191], v[144:147], v[24:27]
v_mfma_f32_16x16x32_bf16 v[28:31], v[188:191], v[148:151], v[28:31]
v_mfma_f32_16x16x32_bf16 v[32:35], v[188:191], v[152:155], v[32:35]
ds_read_b64_tr_b16 v[208:209], v240 offset:128
ds_read_b64_tr_b16 v[210:211], v240 offset:1216
s_waitcnt lgkmcnt(8)
v_mfma_f32_16x16x32_bf16 v[36:39], v[192:195], v[144:147], v[36:39]
v_mfma_f32_16x16x32_bf16 v[40:43], v[192:195], v[148:151], v[40:43]
v_mfma_f32_16x16x32_bf16 v[44:47], v[192:195], v[152:155], v[44:47]
v_add_u32 v241, s39, v241
v_add_u32 v237, s39, v237
v_add_u32 v238, s39, v238
v_add_u32 v239, s39, v239
v_add_u32 v240, s39, v240
s_add_u32 m0, s44, 8192
s_add_u32 s38, s45, 131072
buffer_load_dwordx4 v243, s[20:23], s38 offen lds
s_add_u32 s43, s43, 262144
s_add_u32 s45, s45, 64
s_add_u32 s46, s46, 1
s_and_b32 s46, s46, 3
s_cmp_eq_u32 s46, 0
s_cselect_b32 s38, s68, s69
s_add_u32 s42, s42, s38
s_add_u32 s44, s44, s38
s_waitcnt lgkmcnt(6)
v_mfma_f32_16x16x32_bf16 v[48:51], v[196:199], v[144:147], v[48:51]
v_mfma_f32_16x16x32_bf16 v[52:55], v[196:199], v[148:151], v[52:55]
v_mfma_f32_16x16x32_bf16 v[56:59], v[196:199], v[152:155], v[56:59]
s_waitcnt lgkmcnt(0)
s_waitcnt vmcnt(8)
s_barrier
s_add_u32 s31, s31, 1
s_cmp_lt_u32 s31, 13
s_cbranch_scc1 QL_R0
ds_read_b128 v[168:171], v241 offset:0
ds_read_b64_tr_b16 v[180:181], v237 offset:0
ds_read_b64_tr_b16 v[182:183], v237 offset:1088
ds_read_b128 v[172:175], v241 offset:1024
ds_read_b128 v[176:179], v241 offset:2048
ds_read_b64_tr_b16 v[184:185], v238 offset:0
ds_read_b64_tr_b16 v[186:187], v238 offset:1088
v_mfma_f32_16x16x32_bf16 v[60:63], v[200:203], v[144:147], v[60:63]
v_mfma_f32_16x16x32_bf16 v[64:67], v[200:203], v[148:151], v[64:67]
v_mfma_f32_16x16x32_bf16 v[68:71], v[200:203], v[152:155], v[68:71]
ds_read_b64_tr_b16 v[188:189], v239 offset:0
ds_read_b64_tr_b16 v[190:191], v239 offset:1088
s_mov_b32 m0, s34
s_nop 0
buffer_load_dwordx4 v235, s[8:11], s32 offen nt lds
v_mfma_f32_16x16x32_bf16 v[72:75], v[204:207], v[144:147], v[72:75]
v_mfma_f32_16x16x32_bf16 v[76:79], v[204:207], v[148:151], v[76:79]
v_mfma_f32_16x16x32_bf16 v[80:83], v[204:207], v[152:155], v[80:83]
ds_read_b64_tr_b16 v[192:193], v240 offset:0
ds_read_b64_tr_b16 v[194:195], v240 offset:1088
v_mfma_f32_16x16x32_bf16 v[84:87], v[208:211], v[144:147], v[84:87]
v_mfma_f32_16x16x32_bf16 v[88:91], v[208:211], v[148:151], v[88:91]
v_mfma_f32_16x16x32_bf16 v[92:95], v[208:211], v[152:155], v[92:95]
ds_read_b64_tr_b16 v[196:197], v237 offset:128
ds_read_b64_tr_b16 v[198:199], v237 offset:1216
s_add_u32 m0, s34, 4352
s_add_u32 s38, s32, 4096
buffer_load_dwordx4 v235, s[8:11], s38 offen nt lds
s_add_u32 s32, s32, 8192
s_add_u32 s48, s48, 1
s_and_b32 s48, s48, 3
s_cmp_eq_u32 s48, 0
s_cselect_b32 s38, s66, s67
s_add_u32 s34, s34, s38
s_add_u32 s47, s47, 1
s_and_b32 s47, s47, 3
s_cmp_eq_u32 s47, 0
s_cselect_b32 s39, s68, s69
s_waitcnt lgkmcnt(10)
v_mfma_f32_16x16x32_bf16 v[0:3], v[180:183], v[168:171], v[0:3]
s_waitcnt lgkmcnt(9)
v_mfma_f32_16x16x32_bf16 v[4:7], v[180:183], v[172:175], v[4:7]
s_waitcnt lgkmcnt(8)
v_mfma_f32_16x16x32_bf16 v[8:11], v[180:183], v[176:179], v[8:11]
ds_read_b64_tr_b16 v[200:201], v238 offset:128
ds_read_b64_tr_b16 v[202:203], v238 offset:1216
s_waitcnt lgkmcnt(8)
v_mfma_f32_16x16x32_bf16 v[12:15], v[184:187], v[168:171], v[12:15]
v_mfma_f32_16x16x32_bf16 v[16:19], v[184:187], v[172:175], v[16:19]
v_mfma_f32_16x16x32_bf16 v[20:23], v[184:187], v[176:179], v[20:23]
ds_read_b64_tr_b16 v[204:205], v239 offset:128
ds_read_b64_tr_b16 v[206:207], v239 offset:1216
s_mov_b32 m0, s35
s_nop 0
buffer_load_dwordx4 v236, s[12:15], s33 offen nt lds
s_waitcnt lgkmcnt(8)
v_mfma_f32_16x16x32_bf16 v[24:27], v[188:191], v[168:171], v[24:27]
v_mfma_f32_16x16x32_bf16 v[28:31], v[188:191], v[172:175], v[28:31]
v_mfma_f32_16x16x32_bf16 v[32:35], v[188:191], v[176:179], v[32:35]
ds_read_b64_tr_b16 v[208:209], v240 offset:128
ds_read_b64_tr_b16 v[210:211], v240 offset:1216
s_waitcnt lgkmcnt(8)
v_mfma_f32_16x16x32_bf16 v[36:39], v[192:195], v[168:171], v[36:39]
v_mfma_f32_16x16x32_bf16 v[40:43], v[192:195], v[172:175], v[40:43]
v_mfma_f32_16x16x32_bf16 v[44:47], v[192:195], v[176:179], v[44:47]
v_add_u32 v241, s39, v241
v_add_u32 v237, s39, v237
v_add_u32 v238, s39, v238
v_add_u32 v239, s39, v239
v_add_u32 v240, s39, v240
s_add_u32 m0, s35, 4608
s_add_u32 s38, s33, 4096
buffer_load_dwordx4 v236, s[12:15], s38 offen nt lds
s_add_u32 s33, s33, 8192
s_add_u32 s49, s49, 1
s_and_b32 s49, s49, 3
s_cmp_eq_u32 s49, 0
s_cselect_b32 s38, s66, s67
s_add_u32 s35, s35, s38
s_waitcnt lgkmcnt(6)
v_mfma_f32_16x16x32_bf16 v[48:51], v[196:199], v[168:171], v[48:51]
v_mfma_f32_16x16x32_bf16 v[52:55], v[196:199], v[172:175], v[52:55]
v_mfma_f32_16x16x32_bf16 v[56:59], v[196:199], v[176:179], v[56:59]
s_waitcnt lgkmcnt(0)
s_waitcnt vmcnt(8)
s_barrier
ds_read_b128 v[144:147], v241 offset:0
ds_read_b64_tr_b16 v[180:181], v237 offset:0
ds_read_b64_tr_b16 v[182:183], v237 offset:1088
ds_read_b128 v[148:151], v241 offset:1024
ds_read_b128 v[152:155], v241 offset:2048
ds_read_b64_tr_b16 v[184:185], v238 offset:0
ds_read_b64_tr_b16 v[186:187], v238 offset:1088
v_mfma_f32_16x16x32_bf16 v[60:63], v[200:203], v[168:171], v[60:63]
v_mfma_f32_16x16x32_bf16 v[64:67], v[200:203], v[172:175], v[64:67]
v_mfma_f32_16x16x32_bf16 v[68:71], v[200:203], v[176:179], v[68:71]
ds_read_b64_tr_b16 v[188:189], v239 offset:0
ds_read_b64_tr_b16 v[190:191], v239 offset:1088
v_mfma_f32_16x16x32_bf16 v[72:75], v[204:207], v[168:171], v[72:75]
v_mfma_f32_16x16x32_bf16 v[76:79], v[204:207], v[172:175], v[76:79]
v_mfma_f32_16x16x32_bf16 v[80:83], v[204:207], v[176:179], v[80:83]
ds_read_b64_tr_b16 v[192:193], v240 offset:0
ds_read_b64_tr_b16 v[194:195], v240 offset:1088
v_mfma_f32_16x16x32_bf16 v[84:87], v[208:211], v[168:171], v[84:87]
v_mfma_f32_16x16x32_bf16 v[88:91], v[208:211], v[172:175], v[88:91]
v_mfma_f32_16x16x32_bf16 v[92:95], v[208:211], v[176:179], v[92:95]
ds_read_b64_tr_b16 v[196:197], v237 offset:128
ds_read_b64_tr_b16 v[198:199], v237 offset:1216
s_add_u32 s47, s47, 1
s_and_b32 s47, s47, 3
s_cmp_eq_u32 s47, 0
s_cselect_b32 s39, s68, s69
s_waitcnt lgkmcnt(10)
v_mfma_f32_16x16x32_bf16 v[0:3], v[180:183], v[144:147], v[0:3]
s_waitcnt lgkmcnt(9)
v_mfma_f32_16x16x32_bf16 v[4:7], v[180:183], v[148:151], v[4:7]
s_waitcnt lgkmcnt(8)
v_mfma_f32_16x16x32_bf16 v[8:11], v[180:183], v[152:155], v[8:11]
ds_read_b64_tr_b16 v[200:201], v238 offset:128
ds_read_b64_tr_b16 v[202:203], v238 offset:1216
s_waitcnt lgkmcnt(8)
v_mfma_f32_16x16x32_bf16 v[12:15], v[184:187], v[144:147], v[12:15]
v_mfma_f32_16x16x32_bf16 v[16:19], v[184:187], v[148:151], v[16:19]
v_mfma_f32_16x16x32_bf16 v[20:23], v[184:187], v[152:155], v[20:23]
ds_read_b64_tr_b16 v[204:205], v239 offset:128
ds_read_b64_tr_b16 v[206:207], v239 offset:1216
s_waitcnt lgkmcnt(8)
v_mfma_f32_16x16x32_bf16 v[24:27], v[188:191], v[144:147], v[24:27]
v_mfma_f32_16x16x32_bf16 v[28:31], v[188:191], v[148:151], v[28:31]
v_mfma_f32_16x16x32_bf16 v[32:35], v[188:191], v[152:155], v[32:35]
ds_read_b64_tr_b16 v[208:209], v240 offset:128
ds_read_b64_tr_b16 v[210:211], v240 offset:1216
s_waitcnt lgkmcnt(8)
v_mfma_f32_16x16x32_bf16 v[36:39], v[192:195], v[144:147], v[36:39]
v_mfma_f32_16x16x32_bf16 v[40:43], v[192:195], v[148:151], v[40:43]
v_mfma_f32_16x16x32_bf16 v[44:47], v[192:195], v[152:155], v[44:47]
v_add_u32 v241, s39, v241
v_add_u32 v237, s39, v237
v_add_u32 v238, s39, v238
v_add_u32 v239, s39, v239
v_add_u32 v240, s39, v240
s_waitcnt lgkmcnt(6)
v_mfma_f32_16x16x32_bf16 v[48:51], v[196:199], v[144:147], v[48:51]
v_mfma_f32_16x16x32_bf16 v[52:55], v[196:199], v[148:151], v[52:55]
v_mfma_f32_16x16x32_bf16 v[56:59], v[196:199], v[152:155], v[56:59]
s_waitcnt lgkmcnt(0)
s_waitcnt vmcnt(4)
s_barrier
ds_read_b128 v[168:171], v241 offset:0
ds_read_b64_tr_b16 v[180:181], v237 offset:0
ds_read_b64_tr_b16 v[182:183], v237 offset:1088
ds_read_b128 v[172:175], v241 offset:1024
ds_read_b128 v[176:179], v241 offset:2048
ds_read_b64_tr_b16 v[184:185], v238 offset:0
ds_read_b64_tr_b16 v[186:187], v238 offset:1088
v_mfma_f32_16x16x32_bf16 v[60:63], v[200:203], v[144:147], v[60:63]
v_mfma_f32_16x16x32_bf16 v[64:67], v[200:203], v[148:151], v[64:67]
v_mfma_f32_16x16x32_bf16 v[68:71], v[200:203], v[152:155], v[68:71]
ds_read_b64_tr_b16 v[188:189], v239 offset:0
ds_read_b64_tr_b16 v[190:191], v239 offset:1088
s_mov_b32 m0, s34
s_nop 0
buffer_load_dwordx4 v235, s[8:11], s32 offen nt lds
v_mfma_f32_16x16x32_bf16 v[72:75], v[204:207], v[144:147], v[72:75]
v_mfma_f32_16x16x32_bf16 v[76:79], v[204:207], v[148:151], v[76:79]
v_mfma_f32_16x16x32_bf16 v[80:83], v[204:207], v[152:155], v[80:83]
ds_read_b64_tr_b16 v[192:193], v240 offset:0
ds_read_b64_tr_b16 v[194:195], v240 offset:1088
v_mfma_f32_16x16x32_bf16 v[84:87], v[208:211], v[144:147], v[84:87]
v_mfma_f32_16x16x32_bf16 v[88:91], v[208:211], v[148:151], v[88:91]
v_mfma_f32_16x16x32_bf16 v[92:95], v[208:211], v[152:155], v[92:95]
ds_read_b64_tr_b16 v[196:197], v237 offset:128
ds_read_b64_tr_b16 v[198:199], v237 offset:1216
s_add_u32 m0, s34, 4352
s_add_u32 s38, s32, 4096
buffer_load_dwordx4 v235, s[8:11], s38 offen nt lds
s_add_u32 s32, s32, 8192
s_add_u32 s48, s48, 1
s_and_b32 s48, s48, 3
s_cmp_eq_u32 s48, 0
s_cselect_b32 s38, s66, s67
s_add_u32 s34, s34, s38
s_add_u32 s47, s47, 1
s_and_b32 s47, s47, 3
s_cmp_eq_u32 s47, 0
s_cselect_b32 s39, s68, s69
s_waitcnt lgkmcnt(10)
v_mfma_f32_16x16x32_bf16 v[0:3], v[180:183], v[168:171], v[0:3]
s_waitcnt lgkmcnt(9)
v_mfma_f32_16x16x32_bf16 v[4:7], v[180:183], v[172:175], v[4:7]
s_waitcnt lgkmcnt(8)
v_mfma_f32_16x16x32_bf16 v[8:11], v[180:183], v[176:179], v[8:11]
ds_read_b64_tr_b16 v[200:201], v238 offset:128
ds_read_b64_tr_b16 v[202:203], v238 offset:1216
s_waitcnt lgkmcnt(8)
v_mfma_f32_16x16x32_bf16 v[12:15], v[184:187], v[168:171], v[12:15]
v_mfma_f32_16x16x32_bf16 v[16:19], v[184:187], v[172:175], v[16:19]
v_mfma_f32_16x16x32_bf16 v[20:23], v[184:187], v[176:179], v[20:23]
ds_read_b64_tr_b16 v[204:205], v239 offset:128
ds_read_b64_tr_b16 v[206:207], v239 offset:1216
s_mov_b32 m0, s35
s_nop 0
buffer_load_dwordx4 v236, s[12:15], s33 offen nt lds
s_waitcnt lgkmcnt(8)
v_mfma_f32_16x16x32_bf16 v[24:27], v[188:191], v[168:171], v[24:27]
v_mfma_f32_16x16x32_bf16 v[28:31], v[188:191], v[172:175], v[28:31]
v_mfma_f32_16x16x32_bf16 v[32:35], v[188:191], v[176:179], v[32:35]
ds_read_b64_tr_b16 v[208:209], v240 offset:128
ds_read_b64_tr_b16 v[210:211], v240 offset:1216
s_waitcnt lgkmcnt(8)
v_mfma_f32_16x16x32_bf16 v[36:39], v[192:195], v[168:171], v[36:39]
v_mfma_f32_16x16x32_bf16 v[40:43], v[192:195], v[172:175], v[40:43]
v_mfma_f32_16x16x32_bf16 v[44:47], v[192:195], v[176:179], v[44:47]
v_add_u32 v241, s39, v241
v_add_u32 v237, s39, v237
v_add_u32 v238, s39, v238
v_add_u32 v239, s39, v239
v_add_u32 v240, s39, v240
s_add_u32 m0, s35, 4608
s_add_u32 s38, s33, 4096
buffer_load_dwordx4 v236, s[12:15], s38 offen nt lds
s_add_u32 s33, s33, 8192
s_add_u32 s49, s49, 1
s_and_b32 s49, s49, 3
s_cmp_eq_u32 s49, 0
s_cselect_b32 s38, s66, s67
s_add_u32 s35, s35, s38
s_waitcnt lgkmcnt(6)
v_mfma_f32_16x16x32_bf16 v[48:51], v[196:199], v[168:171], v[48:51]
v_mfma_f32_16x16x32_bf16 v[52:55], v[196:199], v[172:175], v[52:55]
v_mfma_f32_16x16x32_bf16 v[56:59], v[196:199], v[176:179], v[56:59]
s_waitcnt lgkmcnt(0)
s_barrier
v_mfma_f32_16x16x32_bf16 v[60:63], v[200:203], v[168:171], v[60:63]
v_mfma_f32_16x16x32_bf16 v[64:67], v[200:203], v[172:175], v[64:67]
v_mfma_f32_16x16x32_bf16 v[68:71], v[200:203], v[176:179], v[68:71]
v_mfma_f32_16x16x32_bf16 v[72:75], v[204:207], v[168:171], v[72:75]
v_mfma_f32_16x16x32_bf16 v[76:79], v[204:207], v[172:175], v[76:79]
v_mfma_f32_16x16x32_bf16 v[80:83], v[204:207], v[176:179], v[80:83]
v_mfma_f32_16x16x32_bf16 v[84:87], v[208:211], v[168:171], v[84:87]
v_mfma_f32_16x16x32_bf16 v[88:91], v[208:211], v[172:175], v[88:91]
v_mfma_f32_16x16x32_bf16 v[92:95], v[208:211], v[176:179], v[92:95]
s_nop 7
s_mov_b32 s38, 0x3e0293ee
s_mov_b32 s39, 0x3e0293ee
v_pk_mul_f32 v[0:1], v[0:1], s[38:39]
v_pk_mul_f32 v[2:3], v[2:3], s[38:39]
v_cvt_pk_bf16_f32 v96, v0, v1
v_cvt_pk_bf16_f32 v97, v2, v3
v_pk_mul_f32 v[12:13], v[12:13], s[38:39]
v_pk_mul_f32 v[14:15], v[14:15], s[38:39]
v_cvt_pk_bf16_f32 v98, v12, v13
v_cvt_pk_bf16_f32 v99, v14, v15
s_nop 0
v_permlane32_swap_b32 v96, v98
v_permlane32_swap_b32 v97, v99
s_nop 0
v_permlane16_swap_b32 v96, v98
v_permlane16_swap_b32 v97, v99
v_pk_mul_f32 v[4:5], v[4:5], s[38:39]
v_pk_mul_f32 v[6:7], v[6:7], s[38:39]
v_cvt_pk_bf16_f32 v100, v4, v5
v_cvt_pk_bf16_f32 v101, v6, v7
v_pk_mul_f32 v[16:17], v[16:17], s[38:39]
v_pk_mul_f32 v[18:19], v[18:19], s[38:39]
v_cvt_pk_bf16_f32 v102, v16, v17
v_cvt_pk_bf16_f32 v103, v18, v19
s_nop 0
v_permlane32_swap_b32 v100, v102
v_permlane32_swap_b32 v101, v103
s_nop 0
v_permlane16_swap_b32 v100, v102
v_permlane16_swap_b32 v101, v103
v_pk_mul_f32 v[8:9], v[8:9], s[38:39]
v_pk_mul_f32 v[10:11], v[10:11], s[38:39]
v_cvt_pk_bf16_f32 v104, v8, v9
v_cvt_pk_bf16_f32 v105, v10, v11
v_pk_mul_f32 v[20:21], v[20:21], s[38:39]
v_pk_mul_f32 v[22:23], v[22:23], s[38:39]
v_cvt_pk_bf16_f32 v106, v20, v21
v_cvt_pk_bf16_f32 v107, v22, v23
s_nop 0
v_permlane32_swap_b32 v104, v106
v_permlane32_swap_b32 v105, v107
s_nop 0
v_permlane16_swap_b32 v104, v106
v_permlane16_swap_b32 v105, v107
v_pk_mul_f32 v[24:25], v[24:25], s[38:39]
v_pk_mul_f32 v[26:27], v[26:27], s[38:39]
v_cvt_pk_bf16_f32 v108, v24, v25
v_cvt_pk_bf16_f32 v109, v26, v27
v_pk_mul_f32 v[36:37], v[36:37], s[38:39]
v_pk_mul_f32 v[38:39], v[38:39], s[38:39]
v_cvt_pk_bf16_f32 v110, v36, v37
v_cvt_pk_bf16_f32 v111, v38, v39
s_nop 0
v_permlane32_swap_b32 v108, v110
v_permlane32_swap_b32 v109, v111
s_nop 0
v_permlane16_swap_b32 v108, v110
v_permlane16_swap_b32 v109, v111
v_pk_mul_f32 v[28:29], v[28:29], s[38:39]
v_pk_mul_f32 v[30:31], v[30:31], s[38:39]
v_cvt_pk_bf16_f32 v112, v28, v29
v_cvt_pk_bf16_f32 v113, v30, v31
v_pk_mul_f32 v[40:41], v[40:41], s[38:39]
v_pk_mul_f32 v[42:43], v[42:43], s[38:39]
v_cvt_pk_bf16_f32 v114, v40, v41
v_cvt_pk_bf16_f32 v115, v42, v43
s_nop 0
v_permlane32_swap_b32 v112, v114
v_permlane32_swap_b32 v113, v115
s_nop 0
v_permlane16_swap_b32 v112, v114
v_permlane16_swap_b32 v113, v115
v_pk_mul_f32 v[32:33], v[32:33], s[38:39]
v_pk_mul_f32 v[34:35], v[34:35], s[38:39]
v_cvt_pk_bf16_f32 v116, v32, v33
v_cvt_pk_bf16_f32 v117, v34, v35
v_pk_mul_f32 v[44:45], v[44:45], s[38:39]
v_pk_mul_f32 v[46:47], v[46:47], s[38:39]
v_cvt_pk_bf16_f32 v118, v44, v45
v_cvt_pk_bf16_f32 v119, v46, v47
s_nop 0
v_permlane32_swap_b32 v116, v118
v_permlane32_swap_b32 v117, v119
s_nop 0
v_permlane16_swap_b32 v116, v118
v_permlane16_swap_b32 v117, v119
v_pk_mul_f32 v[48:49], v[48:49], s[38:39]
v_pk_mul_f32 v[50:51], v[50:51], s[38:39]
v_cvt_pk_bf16_f32 v120, v48, v49
v_cvt_pk_bf16_f32 v121, v50, v51
v_pk_mul_f32 v[60:61], v[60:61], s[38:39]
v_pk_mul_f32 v[62:63], v[62:63], s[38:39]
v_cvt_pk_bf16_f32 v122, v60, v61
v_cvt_pk_bf16_f32 v123, v62, v63
s_nop 0
v_permlane32_swap_b32 v120, v122
v_permlane32_swap_b32 v121, v123
s_nop 0
v_permlane16_swap_b32 v120, v122
v_permlane16_swap_b32 v121, v123
v_pk_mul_f32 v[52:53], v[52:53], s[38:39]
v_pk_mul_f32 v[54:55], v[54:55], s[38:39]
v_cvt_pk_bf16_f32 v124, v52, v53
v_cvt_pk_bf16_f32 v125, v54, v55
v_pk_mul_f32 v[64:65], v[64:65], s[38:39]
v_pk_mul_f32 v[66:67], v[66:67], s[38:39]
v_cvt_pk_bf16_f32 v126, v64, v65
v_cvt_pk_bf16_f32 v127, v66, v67
s_nop 0
v_permlane32_swap_b32 v124, v126
v_permlane32_swap_b32 v125, v127
s_nop 0
v_permlane16_swap_b32 v124, v126
v_permlane16_swap_b32 v125, v127
v_pk_mul_f32 v[56:57], v[56:57], s[38:39]
v_pk_mul_f32 v[58:59], v[58:59], s[38:39]
v_cvt_pk_bf16_f32 v128, v56, v57
v_cvt_pk_bf16_f32 v129, v58, v59
v_pk_mul_f32 v[68:69], v[68:69], s[38:39]
v_pk_mul_f32 v[70:71], v[70:71], s[38:39]
v_cvt_pk_bf16_f32 v130, v68, v69
v_cvt_pk_bf16_f32 v131, v70, v71
s_nop 0
v_permlane32_swap_b32 v128, v130
v_permlane32_swap_b32 v129, v131
s_nop 0
v_permlane16_swap_b32 v128, v130
v_permlane16_swap_b32 v129, v131
v_pk_mul_f32 v[72:73], v[72:73], s[38:39]
v_pk_mul_f32 v[74:75], v[74:75], s[38:39]
v_cvt_pk_bf16_f32 v132, v72, v73
v_cvt_pk_bf16_f32 v133, v74, v75
v_pk_mul_f32 v[84:85], v[84:85], s[38:39]
v_pk_mul_f32 v[86:87], v[86:87], s[38:39]
v_cvt_pk_bf16_f32 v134, v84, v85
v_cvt_pk_bf16_f32 v135, v86, v87
s_nop 0
v_permlane32_swap_b32 v132, v134
v_permlane32_swap_b32 v133, v135
s_nop 0
v_permlane16_swap_b32 v132, v134
v_permlane16_swap_b32 v133, v135
v_pk_mul_f32 v[76:77], v[76:77], s[38:39]
v_pk_mul_f32 v[78:79], v[78:79], s[38:39]
v_cvt_pk_bf16_f32 v136, v76, v77
v_cvt_pk_bf16_f32 v137, v78, v79
v_pk_mul_f32 v[88:89], v[88:89], s[38:39]
v_pk_mul_f32 v[90:91], v[90:91], s[38:39]
v_cvt_pk_bf16_f32 v138, v88, v89
v_cvt_pk_bf16_f32 v139, v90, v91
s_nop 0
v_permlane32_swap_b32 v136, v138
v_permlane32_swap_b32 v137, v139
s_nop 0
v_permlane16_swap_b32 v136, v138
v_permlane16_swap_b32 v137, v139
v_pk_mul_f32 v[80:81], v[80:81], s[38:39]
v_pk_mul_f32 v[82:83], v[82:83], s[38:39]
v_cvt_pk_bf16_f32 v140, v80, v81
v_cvt_pk_bf16_f32 v141, v82, v83
v_pk_mul_f32 v[92:93], v[92:93], s[38:39]
v_pk_mul_f32 v[94:95], v[94:95], s[38:39]
v_cvt_pk_bf16_f32 v142, v92, v93
v_cvt_pk_bf16_f32 v143, v94, v95
s_nop 0
v_permlane32_swap_b32 v140, v142
v_permlane32_swap_b32 v141, v143
s_nop 0
v_permlane16_swap_b32 v140, v142
v_permlane16_swap_b32 v141, v143
s_mov_b32 m0, s34
s_nop 0
buffer_load_dwordx4 v235, s[8:11], s32 offen nt lds
s_add_u32 s38, s32, 4096
s_add_u32 m0, s34, 4352
s_nop 0
buffer_load_dwordx4 v235, s[8:11], s38 offen nt lds
s_add_u32 s32, s32, 8192
s_add_u32 s48, s48, 1
s_and_b32 s48, s48, 3
s_cmp_eq_u32 s48, 0
s_cselect_b32 s38, s66, s67
s_add_u32 s34, s34, s38
s_mov_b32 m0, s35
s_nop 0
buffer_load_dwordx4 v236, s[12:15], s33 offen nt lds
s_add_u32 s38, s33, 4096
s_add_u32 m0, s35, 4608
s_nop 0
buffer_load_dwordx4 v236, s[12:15], s38 offen nt lds
s_add_u32 s33, s33, 8192
s_add_u32 s49, s49, 1
s_and_b32 s49, s49, 3
s_cmp_eq_u32 s49, 0
s_cselect_b32 s38, s66, s67
s_add_u32 s35, s35, s38
ds_read_b128 v[180:183], v230 offset:0
ds_read_b128 v[184:187], v230 offset:4352
ds_read_b128 v[188:191], v230 offset:64
ds_read_b128 v[192:195], v230 offset:4416
ds_read_b128 v[196:199], v230 offset:128
ds_read_b128 v[200:203], v230 offset:4480
ds_read_b128 v[204:207], v230 offset:192
ds_read_b128 v[208:211], v230 offset:4544
s_waitcnt lgkmcnt(7)
v_mfma_f32_16x16x32_bf16 v[144:147], v[180:183], v[96:99], 0
v_mfma_f32_16x16x32_bf16 v[148:151], v[180:183], v[100:103], 0
v_mfma_f32_16x16x32_bf16 v[152:155], v[180:183], v[104:107], 0
s_waitcnt lgkmcnt(6)
v_mfma_f32_16x16x32_bf16 v[156:159], v[184:187], v[96:99], 0
v_mfma_f32_16x16x32_bf16 v[160:163], v[184:187], v[100:103], 0
v_mfma_f32_16x16x32_bf16 v[164:167], v[184:187], v[104:107], 0
s_waitcnt lgkmcnt(5)
v_mfma_f32_16x16x32_bf16 v[144:147], v[188:191], v[108:111], v[144:147]
v_mfma_f32_16x16x32_bf16 v[148:151], v[188:191], v[112:115], v[148:151]
v_mfma_f32_16x16x32_bf16 v[152:155], v[188:191], v[116:119], v[152:155]
s_waitcnt lgkmcnt(4)
v_mfma_f32_16x16x32_bf16 v[156:159], v[192:195], v[108:111], v[156:159]
v_mfma_f32_16x16x32_bf16 v[160:163], v[192:195], v[112:115], v[160:163]
v_mfma_f32_16x16x32_bf16 v[164:167], v[192:195], v[116:119], v[164:167]
s_waitcnt lgkmcnt(3)
v_mfma_f32_16x16x32_bf16 v[144:147], v[196:199], v[120:123], v[144:147]
v_mfma_f32_16x16x32_bf16 v[148:151], v[196:199], v[124:127], v[148:151]
v_mfma_f32_16x16x32_bf16 v[152:155], v[196:199], v[128:131], v[152:155]
s_waitcnt lgkmcnt(2)
v_mfma_f32_16x16x32_bf16 v[156:159], v[200:203], v[120:123], v[156:159]
v_mfma_f32_16x16x32_bf16 v[160:163], v[200:203], v[124:127], v[160:163]
v_mfma_f32_16x16x32_bf16 v[164:167], v[200:203], v[128:131], v[164:167]
s_waitcnt lgkmcnt(1)
v_mfma_f32_16x16x32_bf16 v[144:147], v[204:207], v[132:135], v[144:147]
v_mfma_f32_16x16x32_bf16 v[148:151], v[204:207], v[136:139], v[148:151]
v_mfma_f32_16x16x32_bf16 v[152:155], v[204:207], v[140:143], v[152:155]
s_waitcnt lgkmcnt(0)
v_mfma_f32_16x16x32_bf16 v[156:159], v[208:211], v[132:135], v[156:159]
v_mfma_f32_16x16x32_bf16 v[160:163], v[208:211], v[136:139], v[160:163]
v_mfma_f32_16x16x32_bf16 v[164:167], v[208:211], v[140:143], v[164:167]
s_nop 1
v_max3_f32 v227, v144, v145, v146
s_nop 2
v_max3_f32 v227, v227, v147, v156
v_max3_f32 v227, v227, v157, v158
v_max_f32 v227, v227, v159
v_max3_f32 v228, v148, v149, v150
v_max3_f32 v228, v228, v151, v160
v_max3_f32 v228, v228, v161, v162
v_max_f32 v228, v228, v163
v_max3_f32 v229, v152, v153, v154
v_max3_f32 v229, v229, v155, v164
v_max3_f32 v229, v229, v165, v166
v_max_f32 v229, v229, v167
v_mov_b32 v244, v227
v_mov_b32 v245, v228
v_mov_b32 v246, v229
v_permlane32_swap_b32 v227, v244
v_permlane32_swap_b32 v228, v245
v_permlane32_swap_b32 v229, v246
v_max_f32 v227, v227, v244
v_max_f32 v228, v228, v245
v_max_f32 v229, v229, v246
v_mov_b32 v244, v227
v_mov_b32 v245, v228
v_mov_b32 v246, v229
v_permlane16_swap_b32 v227, v244
v_permlane16_swap_b32 v228, v245
v_permlane16_swap_b32 v229, v246
v_max_f32 v227, v227, v244
v_max_f32 v228, v228, v245
v_max_f32 v229, v229, v246
v_sub_f32 v144, v144, v227
v_sub_f32 v145, v145, v227
v_sub_f32 v146, v146, v227
v_sub_f32 v147, v147, v227
v_sub_f32 v156, v156, v227
v_sub_f32 v157, v157, v227
v_sub_f32 v158, v158, v227
v_sub_f32 v159, v159, v227
v_sub_f32 v148, v148, v228
v_sub_f32 v149, v149, v228
v_sub_f32 v150, v150, v228
v_sub_f32 v151, v151, v228
v_sub_f32 v160, v160, v228
v_sub_f32 v161, v161, v228
v_sub_f32 v162, v162, v228
v_sub_f32 v163, v163, v228
v_sub_f32 v152, v152, v229
v_sub_f32 v153, v153, v229
v_sub_f32 v154, v154, v229
v_sub_f32 v155, v155, v229
v_sub_f32 v164, v164, v229
v_sub_f32 v165, v165, v229
v_sub_f32 v166, v166, v229
v_sub_f32 v167, v167, v229
v_sub_f32 v212, 0, v227
v_sub_f32 v213, 0, v227
v_sub_f32 v214, 0, v227
v_sub_f32 v215, 0, v227
v_mov_b32 v224, 0
v_sub_f32 v216, 0, v228
v_sub_f32 v217, 0, v228
v_sub_f32 v218, 0, v228
v_sub_f32 v219, 0, v228
v_mov_b32 v225, 0
v_sub_f32 v220, 0, v229
v_sub_f32 v221, 0, v229
v_sub_f32 v222, 0, v229
v_sub_f32 v223, 0, v229
v_mov_b32 v226, 0
v_exp_f32 v144, v144
v_exp_f32 v145, v145
v_exp_f32 v146, v146
v_exp_f32 v147, v147
v_exp_f32 v156, v156
v_exp_f32 v157, v157
v_exp_f32 v158, v158
v_exp_f32 v159, v159
v_exp_f32 v148, v148
v_exp_f32 v149, v149
v_exp_f32 v150, v150
v_exp_f32 v151, v151
v_exp_f32 v160, v160
v_exp_f32 v161, v161
v_exp_f32 v162, v162
v_exp_f32 v163, v163
v_exp_f32 v152, v152
v_exp_f32 v153, v153
v_exp_f32 v154, v154
v_exp_f32 v155, v155
v_exp_f32 v164, v164
v_exp_f32 v165, v165
v_exp_f32 v166, v166
v_exp_f32 v167, v167
v_add_f32 v227, v144, v145
v_add_f32 v244, v146, v147
v_add_f32 v228, v148, v149
v_add_f32 v245, v150, v151
v_add_f32 v229, v152, v153
v_add_f32 v246, v154, v155
v_add_f32 v227, v227, v156
v_add_f32 v244, v244, v157
v_add_f32 v228, v228, v160
v_add_f32 v245, v245, v161
v_add_f32 v229, v229, v164
v_add_f32 v246, v246, v165
v_add_f32 v227, v227, v158
v_add_f32 v244, v244, v159
v_add_f32 v228, v228, v162
v_add_f32 v245, v245, v163
v_add_f32 v229, v229, v166
v_add_f32 v246, v246, v167
v_add_f32 v227, v227, v244
v_add_f32 v228, v228, v245
v_add_f32 v229, v229, v246
ds_read_b64_tr_b16 v[180:181], v231 offset:0
ds_read_b64_tr_b16 v[182:183], v231 offset:4608
ds_read_b64_tr_b16 v[184:185], v232 offset:0
ds_read_b64_tr_b16 v[186:187], v232 offset:4608
ds_read_b64_tr_b16 v[188:189], v233 offset:0
ds_read_b64_tr_b16 v[190:191], v233 offset:4608
ds_read_b64_tr_b16 v[192:193], v234 offset:0
ds_read_b64_tr_b16 v[194:195], v234 offset:4608
v_cvt_pk_bf16_f32 v168, v144, v145
v_cvt_pk_bf16_f32 v169, v146, v147
v_cvt_pk_bf16_f32 v170, v156, v157
v_cvt_pk_bf16_f32 v171, v158, v159
v_cvt_pk_bf16_f32 v172, v148, v149
v_cvt_pk_bf16_f32 v173, v150, v151
v_cvt_pk_bf16_f32 v174, v160, v161
v_cvt_pk_bf16_f32 v175, v162, v163
v_cvt_pk_bf16_f32 v176, v152, v153
v_cvt_pk_bf16_f32 v177, v154, v155
v_cvt_pk_bf16_f32 v178, v164, v165
v_cvt_pk_bf16_f32 v179, v166, v167
v_add_f32 v224, v224, v227
v_add_f32 v225, v225, v228
v_add_f32 v226, v226, v229
s_waitcnt lgkmcnt(6)
v_mfma_f32_16x16x32_bf16 v[0:3], v[180:183], v[168:171], 0
v_mfma_f32_16x16x32_bf16 v[4:7], v[180:183], v[172:175], 0
v_mfma_f32_16x16x32_bf16 v[8:11], v[180:183], v[176:179], 0
ds_read_b64_tr_b16 v[196:197], v231 offset:128
ds_read_b64_tr_b16 v[198:199], v231 offset:4736
s_waitcnt lgkmcnt(6)
v_mfma_f32_16x16x32_bf16 v[12:15], v[184:187], v[168:171], 0
v_mfma_f32_16x16x32_bf16 v[16:19], v[184:187], v[172:175], 0
v_mfma_f32_16x16x32_bf16 v[20:23], v[184:187], v[176:179], 0
ds_read_b64_tr_b16 v[200:201], v232 offset:128
ds_read_b64_tr_b16 v[202:203], v232 offset:4736
s_waitcnt lgkmcnt(6)
v_mfma_f32_16x16x32_bf16 v[24:27], v[188:191], v[168:171], 0
v_mfma_f32_16x16x32_bf16 v[28:31], v[188:191], v[172:175], 0
v_mfma_f32_16x16x32_bf16 v[32:35], v[188:191], v[176:179], 0
ds_read_b64_tr_b16 v[204:205], v233 offset:128
ds_read_b64_tr_b16 v[206:207], v233 offset:4736
s_waitcnt lgkmcnt(6)
v_mfma_f32_16x16x32_bf16 v[36:39], v[192:195], v[168:171], 0
v_mfma_f32_16x16x32_bf16 v[40:43], v[192:195], v[172:175], 0
v_mfma_f32_16x16x32_bf16 v[44:47], v[192:195], v[176:179], 0
ds_read_b64_tr_b16 v[208:209], v234 offset:128
ds_read_b64_tr_b16 v[210:211], v234 offset:4736
s_waitcnt lgkmcnt(6)
v_mfma_f32_16x16x32_bf16 v[48:51], v[196:199], v[168:171], 0
v_mfma_f32_16x16x32_bf16 v[52:55], v[196:199], v[172:175], 0
v_mfma_f32_16x16x32_bf16 v[56:59], v[196:199], v[176:179], 0
s_waitcnt lgkmcnt(4)
v_mfma_f32_16x16x32_bf16 v[60:63], v[200:203], v[168:171], 0
v_mfma_f32_16x16x32_bf16 v[64:67], v[200:203], v[172:175], 0
v_mfma_f32_16x16x32_bf16 v[68:71], v[200:203], v[176:179], 0
s_waitcnt lgkmcnt(2)
v_mfma_f32_16x16x32_bf16 v[72:75], v[204:207], v[168:171], 0
v_mfma_f32_16x16x32_bf16 v[76:79], v[204:207], v[172:175], 0
v_mfma_f32_16x16x32_bf16 v[80:83], v[204:207], v[176:179], 0
s_waitcnt lgkmcnt(0)
v_mfma_f32_16x16x32_bf16 v[84:87], v[208:211], v[168:171], 0
v_mfma_f32_16x16x32_bf16 v[88:91], v[208:211], v[172:175], 0
v_mfma_f32_16x16x32_bf16 v[92:95], v[208:211], v[176:179], 0
s_add_u32 s50, s50, 1
s_and_b32 s50, s50, 3
s_cmp_eq_u32 s50, 0
s_cselect_b32 s39, s66, s67
v_add_u32 v230, s39, v230
s_add_u32 s51, s51, 1
s_and_b32 s51, s51, 3
s_cmp_eq_u32 s51, 0
s_cselect_b32 s39, s66, s67
v_add_u32 v231, s39, v231
v_add_u32 v232, s39, v232
v_add_u32 v233, s39, v233
v_add_u32 v234, s39, v234
s_waitcnt vmcnt(8)
s_barrier
s_mov_b32 s31, 1
LOOP_R0:
s_cmp_gt_u32 s31, 12
s_cbranch_scc1 NOK_R0
s_mov_b32 m0, s34
s_nop 0
buffer_load_dwordx4 v235, s[8:11], s32 offen nt lds
s_add_u32 s38, s32, 4096
s_add_u32 m0, s34, 4352
s_nop 0
buffer_load_dwordx4 v235, s[8:11], s38 offen nt lds
s_add_u32 s32, s32, 8192
s_add_u32 s48, s48, 1
s_and_b32 s48, s48, 3
s_cmp_eq_u32 s48, 0
s_cselect_b32 s38, s66, s67
s_add_u32 s34, s34, s38
s_mov_b32 m0, s35
s_nop 0
buffer_load_dwordx4 v236, s[12:15], s33 offen nt lds
s_add_u32 s38, s33, 4096
s_add_u32 m0, s35, 4608
s_nop 0
buffer_load_dwordx4 v236, s[12:15], s38 offen nt lds
s_add_u32 s33, s33, 8192
s_add_u32 s49, s49, 1
s_and_b32 s49, s49, 3
s_cmp_eq_u32 s49, 0
s_cselect_b32 s38, s66, s67
s_add_u32 s35, s35, s38
NOK_R0:
s_setprio 1
ds_read_b128 v[180:183], v230 offset:0
ds_read_b128 v[184:187], v230 offset:4352
ds_read_b128 v[188:191], v230 offset:64
ds_read_b128 v[192:195], v230 offset:4416
ds_read_b128 v[196:199], v230 offset:128
ds_read_b128 v[200:203], v230 offset:4480
ds_read_b128 v[204:207], v230 offset:192
ds_read_b128 v[208:211], v230 offset:4544
s_waitcnt lgkmcnt(7)
v_mfma_f32_16x16x32_bf16 v[144:147], v[180:183], v[96:99], v[212:215]
v_mfma_f32_16x16x32_bf16 v[148:151], v[180:183], v[100:103], v[216:219]
v_mfma_f32_16x16x32_bf16 v[152:155], v[180:183], v[104:107], v[220:223]
s_waitcnt lgkmcnt(6)
v_mfma_f32_16x16x32_bf16 v[156:159], v[184:187], v[96:99], v[212:215]
v_mfma_f32_16x16x32_bf16 v[160:163], v[184:187], v[100:103], v[216:219]
v_mfma_f32_16x16x32_bf16 v[164:167], v[184:187], v[104:107], v[220:223]
s_waitcnt lgkmcnt(5)
v_mfma_f32_16x16x32_bf16 v[144:147], v[188:191], v[108:111], v[144:147]
v_mfma_f32_16x16x32_bf16 v[148:151], v[188:191], v[112:115], v[148:151]
v_mfma_f32_16x16x32_bf16 v[152:155], v[188:191], v[116:119], v[152:155]
s_waitcnt lgkmcnt(4)
v_mfma_f32_16x16x32_bf16 v[156:159], v[192:195], v[108:111], v[156:159]
v_mfma_f32_16x16x32_bf16 v[160:163], v[192:195], v[112:115], v[160:163]
v_mfma_f32_16x16x32_bf16 v[164:167], v[192:195], v[116:119], v[164:167]
s_waitcnt lgkmcnt(3)
v_mfma_f32_16x16x32_bf16 v[144:147], v[196:199], v[120:123], v[144:147]
v_mfma_f32_16x16x32_bf16 v[148:151], v[196:199], v[124:127], v[148:151]
v_mfma_f32_16x16x32_bf16 v[152:155], v[196:199], v[128:131], v[152:155]
s_waitcnt lgkmcnt(2)
v_mfma_f32_16x16x32_bf16 v[156:159], v[200:203], v[120:123], v[156:159]
v_mfma_f32_16x16x32_bf16 v[160:163], v[200:203], v[124:127], v[160:163]
v_mfma_f32_16x16x32_bf16 v[164:167], v[200:203], v[128:131], v[164:167]
s_waitcnt lgkmcnt(1)
v_mfma_f32_16x16x32_bf16 v[144:147], v[204:207], v[132:135], v[144:147]
v_mfma_f32_16x16x32_bf16 v[148:151], v[204:207], v[136:139], v[148:151]
v_mfma_f32_16x16x32_bf16 v[152:155], v[204:207], v[140:143], v[152:155]
s_waitcnt lgkmcnt(0)
v_mfma_f32_16x16x32_bf16 v[156:159], v[208:211], v[132:135], v[156:159]
v_mfma_f32_16x16x32_bf16 v[160:163], v[208:211], v[136:139], v[160:163]
v_mfma_f32_16x16x32_bf16 v[164:167], v[208:211], v[140:143], v[164:167]
s_setprio 0
SM_R0:
s_nop 0
v_exp_f32 v144, v144
v_exp_f32 v145, v145
v_exp_f32 v146, v146
v_exp_f32 v147, v147
v_exp_f32 v156, v156
v_exp_f32 v157, v157
v_exp_f32 v158, v158
v_exp_f32 v159, v159
v_exp_f32 v148, v148
v_exp_f32 v149, v149
v_exp_f32 v150, v150
v_exp_f32 v151, v151
v_exp_f32 v160, v160
v_exp_f32 v161, v161
v_exp_f32 v162, v162
v_exp_f32 v163, v163
v_exp_f32 v152, v152
v_exp_f32 v153, v153
v_exp_f32 v154, v154
v_exp_f32 v155, v155
v_exp_f32 v164, v164
v_exp_f32 v165, v165
v_exp_f32 v166, v166
v_exp_f32 v167, v167
v_add_f32 v227, v144, v145
v_add_f32 v244, v146, v147
v_add_f32 v228, v148, v149
v_add_f32 v245, v150, v151
v_add_f32 v229, v152, v153
v_add_f32 v246, v154, v155
v_add_f32 v227, v227, v156
v_add_f32 v244, v244, v157
v_add_f32 v228, v228, v160
v_add_f32 v245, v245, v161
v_add_f32 v229, v229, v164
v_add_f32 v246, v246, v165
v_add_f32 v227, v227, v158
v_add_f32 v244, v244, v159
v_add_f32 v228, v228, v162
v_add_f32 v245, v245, v163
v_add_f32 v229, v229, v166
v_add_f32 v246, v246, v167
v_add_f32 v227, v227, v244
v_add_f32 v228, v228, v245
v_add_f32 v229, v229, v246
v_max3_f32 v244, v227, v228, v229
v_cmp_lt_f32 vcc, s37, v244
s_nop 1
s_cbranch_vccnz RARE_R0
ds_read_b64_tr_b16 v[180:181], v231 offset:0
ds_read_b64_tr_b16 v[182:183], v231 offset:4608
ds_read_b64_tr_b16 v[184:185], v232 offset:0
ds_read_b64_tr_b16 v[186:187], v232 offset:4608
ds_read_b64_tr_b16 v[188:189], v233 offset:0
ds_read_b64_tr_b16 v[190:191], v233 offset:4608
ds_read_b64_tr_b16 v[192:193], v234 offset:0
ds_read_b64_tr_b16 v[194:195], v234 offset:4608
v_cvt_pk_bf16_f32 v168, v144, v145
v_cvt_pk_bf16_f32 v169, v146, v147
v_cvt_pk_bf16_f32 v170, v156, v157
v_cvt_pk_bf16_f32 v171, v158, v159
v_cvt_pk_bf16_f32 v172, v148, v149
v_cvt_pk_bf16_f32 v173, v150, v151
v_cvt_pk_bf16_f32 v174, v160, v161
v_cvt_pk_bf16_f32 v175, v162, v163
v_cvt_pk_bf16_f32 v176, v152, v153
v_cvt_pk_bf16_f32 v177, v154, v155
v_cvt_pk_bf16_f32 v178, v164, v165
v_cvt_pk_bf16_f32 v179, v166, v167
v_add_f32 v224, v224, v227
v_add_f32 v225, v225, v228
v_add_f32 v226, v226, v229
s_waitcnt lgkmcnt(6)
v_mfma_f32_16x16x32_bf16 v[0:3], v[180:183], v[168:171], v[0:3]
v_mfma_f32_16x16x32_bf16 v[4:7], v[180:183], v[172:175], v[4:7]
v_mfma_f32_16x16x32_bf16 v[8:11], v[180:183], v[176:179], v[8:11]
ds_read_b64_tr_b16 v[196:197], v231 offset:128
ds_read_b64_tr_b16 v[198:199], v231 offset:4736
s_waitcnt lgkmcnt(6)
v_mfma_f32_16x16x32_bf16 v[12:15], v[184:187], v[168:171], v[12:15]
v_mfma_f32_16x16x32_bf16 v[16:19], v[184:187], v[172:175], v[16:19]
v_mfma_f32_16x16x32_bf16 v[20:23], v[184:187], v[176:179], v[20:23]
ds_read_b64_tr_b16 v[200:201], v232 offset:128
ds_read_b64_tr_b16 v[202:203], v232 offset:4736
s_waitcnt lgkmcnt(6)
v_mfma_f32_16x16x32_bf16 v[24:27], v[188:191], v[168:171], v[24:27]
v_mfma_f32_16x16x32_bf16 v[28:31], v[188:191], v[172:175], v[28:31]
v_mfma_f32_16x16x32_bf16 v[32:35], v[188:191], v[176:179], v[32:35]
ds_read_b64_tr_b16 v[204:205], v233 offset:128
ds_read_b64_tr_b16 v[206:207], v233 offset:4736
s_waitcnt lgkmcnt(6)
v_mfma_f32_16x16x32_bf16 v[36:39], v[192:195], v[168:171], v[36:39]
v_mfma_f32_16x16x32_bf16 v[40:43], v[192:195], v[172:175], v[40:43]
v_mfma_f32_16x16x32_bf16 v[44:47], v[192:195], v[176:179], v[44:47]
ds_read_b64_tr_b16 v[208:209], v234 offset:128
ds_read_b64_tr_b16 v[210:211], v234 offset:4736
s_waitcnt lgkmcnt(6)
v_mfma_f32_16x16x32_bf16 v[48:51], v[196:199], v[168:171], v[48:51]
v_mfma_f32_16x16x32_bf16 v[52:55], v[196:199], v[172:175], v[52:55]
v_mfma_f32_16x16x32_bf16 v[56:59], v[196:199], v[176:179], v[56:59]
s_waitcnt lgkmcnt(4)
v_mfma_f32_16x16x32_bf16 v[60:63], v[200:203], v[168:171], v[60:63]
v_mfma_f32_16x16x32_bf16 v[64:67], v[200:203], v[172:175], v[64:67]
v_mfma_f32_16x16x32_bf16 v[68:71], v[200:203], v[176:179], v[68:71]
s_waitcnt lgkmcnt(2)
v_mfma_f32_16x16x32_bf16 v[72:75], v[204:207], v[168:171], v[72:75]
v_mfma_f32_16x16x32_bf16 v[76:79], v[204:207], v[172:175], v[76:79]
v_mfma_f32_16x16x32_bf16 v[80:83], v[204:207], v[176:179], v[80:83]
s_waitcnt lgkmcnt(0)
v_mfma_f32_16x16x32_bf16 v[84:87], v[208:211], v[168:171], v[84:87]
v_mfma_f32_16x16x32_bf16 v[88:91], v[208:211], v[172:175], v[88:91]
v_mfma_f32_16x16x32_bf16 v[92:95], v[208:211], v[176:179], v[92:95]
s_add_u32 s50, s50, 1
s_and_b32 s50, s50, 3
s_cmp_eq_u32 s50, 0
s_cselect_b32 s39, s66, s67
v_add_u32 v230, s39, v230
s_add_u32 s51, s51, 1
s_and_b32 s51, s51, 3
s_cmp_eq_u32 s51, 0
s_cselect_b32 s39, s66, s67
v_add_u32 v231, s39, v231
v_add_u32 v232, s39, v232
v_add_u32 v233, s39, v233
v_add_u32 v234, s39, v234
s_cmp_gt_u32 s31, 12
s_cbranch_scc1 TAILW_R0
s_waitcnt vmcnt(8)
s_branch WD_R0
TAILW_R0:
s_waitcnt vmcnt(4)
s_cmp_eq_u32 s31, 13
s_cbranch_scc1 WD_R0
s_waitcnt vmcnt(0)
WD_R0:
s_barrier
s_add_u32 s31, s31, 1
s_cmp_lt_u32 s31, 16
s_cbranch_scc1 LOOP_R0
v_mov_b32 v244, v224
v_mov_b32 v245, v225
v_mov_b32 v246, v226
v_permlane32_swap_b32 v224, v244
v_permlane32_swap_b32 v225, v245
v_permlane32_swap_b32 v226, v246
v_add_f32 v224, v224, v244
v_add_f32 v225, v225, v245
v_add_f32 v226, v226, v246
v_mov_b32 v244, v224
v_mov_b32 v245, v225
v_mov_b32 v246, v226
v_permlane16_swap_b32 v224, v244
v_permlane16_swap_b32 v225, v245
v_permlane16_swap_b32 v226, v246
v_add_f32 v224, v224, v244
v_add_f32 v225, v225, v245
v_add_f32 v226, v226, v246
v_rcp_f32 v224, v224
v_rcp_f32 v225, v225
v_rcp_f32 v226, v226
v_mov_b32 v212, v224
v_mov_b32 v213, v224
v_mov_b32 v216, v225
v_mov_b32 v217, v225
v_mov_b32 v220, v226
v_mov_b32 v221, v226
v_and_b32 v248, 63, v255
v_lshlrev_b32 v248, 4, v248
v_pk_mul_f32 v[0:1], v[0:1], v[212:213]
v_pk_mul_f32 v[2:3], v[2:3], v[212:213]
v_cvt_pk_bf16_f32 v144, v0, v1
v_cvt_pk_bf16_f32 v145, v2, v3
v_pk_mul_f32 v[12:13], v[12:13], v[212:213]
v_pk_mul_f32 v[14:15], v[14:15], v[212:213]
v_cvt_pk_bf16_f32 v146, v12, v13
v_cvt_pk_bf16_f32 v147, v14, v15
s_add_u32 s38, s36, 0
buffer_store_dwordx4 v[144:147], v248, s[24:27], s38 offen sc0 sc1
v_pk_mul_f32 v[24:25], v[24:25], v[212:213]
v_pk_mul_f32 v[26:27], v[26:27], v[212:213]
v_cvt_pk_bf16_f32 v148, v24, v25
v_cvt_pk_bf16_f32 v149, v26, v27
v_pk_mul_f32 v[36:37], v[36:37], v[212:213]
v_pk_mul_f32 v[38:39], v[38:39], v[212:213]
v_cvt_pk_bf16_f32 v150, v36, v37
v_cvt_pk_bf16_f32 v151, v38, v39
s_add_u32 s38, s36, 1024
buffer_store_dwordx4 v[148:151], v248, s[24:27], s38 offen sc0 sc1
v_pk_mul_f32 v[48:49], v[48:49], v[212:213]
v_pk_mul_f32 v[50:51], v[50:51], v[212:213]
v_cvt_pk_bf16_f32 v152, v48, v49
v_cvt_pk_bf16_f32 v153, v50, v51
v_pk_mul_f32 v[60:61], v[60:61], v[212:213]
v_pk_mul_f32 v[62:63], v[62:63], v[212:213]
v_cvt_pk_bf16_f32 v154, v60, v61
v_cvt_pk_bf16_f32 v155, v62, v63
s_add_u32 s38, s36, 2048
buffer_store_dwordx4 v[152:155], v248, s[24:27], s38 offen sc0 sc1
v_pk_mul_f32 v[72:73], v[72:73], v[212:213]
v_pk_mul_f32 v[74:75], v[74:75], v[212:213]
v_cvt_pk_bf16_f32 v156, v72, v73
v_cvt_pk_bf16_f32 v157, v74, v75
v_pk_mul_f32 v[84:85], v[84:85], v[212:213]
v_pk_mul_f32 v[86:87], v[86:87], v[212:213]
v_cvt_pk_bf16_f32 v158, v84, v85
v_cvt_pk_bf16_f32 v159, v86, v87
s_add_u32 s38, s36, 3072
buffer_store_dwordx4 v[156:159], v248, s[24:27], s38 offen sc0 sc1
v_pk_mul_f32 v[4:5], v[4:5], v[216:217]
v_pk_mul_f32 v[6:7], v[6:7], v[216:217]
v_cvt_pk_bf16_f32 v160, v4, v5
v_cvt_pk_bf16_f32 v161, v6, v7
v_pk_mul_f32 v[16:17], v[16:17], v[216:217]
v_pk_mul_f32 v[18:19], v[18:19], v[216:217]
v_cvt_pk_bf16_f32 v162, v16, v17
v_cvt_pk_bf16_f32 v163, v18, v19
s_add_u32 s38, s36, 4096
buffer_store_dwordx4 v[160:163], v248, s[24:27], s38 offen sc0 sc1
v_pk_mul_f32 v[28:29], v[28:29], v[216:217]
v_pk_mul_f32 v[30:31], v[30:31], v[216:217]
v_cvt_pk_bf16_f32 v164, v28, v29
v_cvt_pk_bf16_f32 v165, v30, v31
v_pk_mul_f32 v[40:41], v[40:41], v[216:217]
v_pk_mul_f32 v[42:43], v[42:43], v[216:217]
v_cvt_pk_bf16_f32 v166, v40, v41
v_cvt_pk_bf16_f32 v167, v42, v43
s_add_u32 s38, s36, 5120
buffer_store_dwordx4 v[164:167], v248, s[24:27], s38 offen sc0 sc1
v_pk_mul_f32 v[52:53], v[52:53], v[216:217]
v_pk_mul_f32 v[54:55], v[54:55], v[216:217]
v_cvt_pk_bf16_f32 v144, v52, v53
v_cvt_pk_bf16_f32 v145, v54, v55
v_pk_mul_f32 v[64:65], v[64:65], v[216:217]
v_pk_mul_f32 v[66:67], v[66:67], v[216:217]
v_cvt_pk_bf16_f32 v146, v64, v65
v_cvt_pk_bf16_f32 v147, v66, v67
s_add_u32 s38, s36, 6144
buffer_store_dwordx4 v[144:147], v248, s[24:27], s38 offen sc0 sc1
v_pk_mul_f32 v[76:77], v[76:77], v[216:217]
v_pk_mul_f32 v[78:79], v[78:79], v[216:217]
v_cvt_pk_bf16_f32 v148, v76, v77
v_cvt_pk_bf16_f32 v149, v78, v79
v_pk_mul_f32 v[88:89], v[88:89], v[216:217]
v_pk_mul_f32 v[90:91], v[90:91], v[216:217]
v_cvt_pk_bf16_f32 v150, v88, v89
v_cvt_pk_bf16_f32 v151, v90, v91
s_add_u32 s38, s36, 7168
buffer_store_dwordx4 v[148:151], v248, s[24:27], s38 offen sc0 sc1
v_pk_mul_f32 v[8:9], v[8:9], v[220:221]
v_pk_mul_f32 v[10:11], v[10:11], v[220:221]
v_cvt_pk_bf16_f32 v152, v8, v9
v_cvt_pk_bf16_f32 v153, v10, v11
v_pk_mul_f32 v[20:21], v[20:21], v[220:221]
v_pk_mul_f32 v[22:23], v[22:23], v[220:221]
v_cvt_pk_bf16_f32 v154, v20, v21
v_cvt_pk_bf16_f32 v155, v22, v23
s_add_u32 s38, s36, 8192
buffer_store_dwordx4 v[152:155], v248, s[24:27], s38 offen sc0 sc1
v_pk_mul_f32 v[32:33], v[32:33], v[220:221]
v_pk_mul_f32 v[34:35], v[34:35], v[220:221]
v_cvt_pk_bf16_f32 v156, v32, v33
v_cvt_pk_bf16_f32 v157, v34, v35
v_pk_mul_f32 v[44:45], v[44:45], v[220:221]
v_pk_mul_f32 v[46:47], v[46:47], v[220:221]
v_cvt_pk_bf16_f32 v158, v44, v45
v_cvt_pk_bf16_f32 v159, v46, v47
s_add_u32 s38, s36, 9216
buffer_store_dwordx4 v[156:159], v248, s[24:27], s38 offen sc0 sc1
v_pk_mul_f32 v[56:57], v[56:57], v[220:221]
v_pk_mul_f32 v[58:59], v[58:59], v[220:221]
v_cvt_pk_bf16_f32 v160, v56, v57
v_cvt_pk_bf16_f32 v161, v58, v59
v_pk_mul_f32 v[68:69], v[68:69], v[220:221]
v_pk_mul_f32 v[70:71], v[70:71], v[220:221]
v_cvt_pk_bf16_f32 v162, v68, v69
v_cvt_pk_bf16_f32 v163, v70, v71
s_add_u32 s38, s36, 10240
buffer_store_dwordx4 v[160:163], v248, s[24:27], s38 offen sc0 sc1
v_pk_mul_f32 v[80:81], v[80:81], v[220:221]
v_pk_mul_f32 v[82:83], v[82:83], v[220:221]
v_cvt_pk_bf16_f32 v164, v80, v81
v_cvt_pk_bf16_f32 v165, v82, v83
v_pk_mul_f32 v[92:93], v[92:93], v[220:221]
v_pk_mul_f32 v[94:95], v[94:95], v[220:221]
v_cvt_pk_bf16_f32 v166, v92, v93
v_cvt_pk_bf16_f32 v167, v94, v95
s_add_u32 s38, s36, 11264
buffer_store_dwordx4 v[164:167], v248, s[24:27], s38 offen sc0 sc1
s_branch K1_END
RARE_R0:
s_waitcnt lgkmcnt(0)
ds_read_b128 v[180:183], v230 offset:0
ds_read_b128 v[184:187], v230 offset:4352
ds_read_b128 v[188:191], v230 offset:64
ds_read_b128 v[192:195], v230 offset:4416
ds_read_b128 v[196:199], v230 offset:128
ds_read_b128 v[200:203], v230 offset:4480
ds_read_b128 v[204:207], v230 offset:192
ds_read_b128 v[208:211], v230 offset:4544
s_waitcnt lgkmcnt(7)
v_mfma_f32_16x16x32_bf16 v[144:147], v[180:183], v[96:99], v[212:215]
v_mfma_f32_16x16x32_bf16 v[148:151], v[180:183], v[100:103], v[216:219]
v_mfma_f32_16x16x32_bf16 v[152:155], v[180:183], v[104:107], v[220:223]
s_waitcnt lgkmcnt(6)
v_mfma_f32_16x16x32_bf16 v[156:159], v[184:187], v[96:99], v[212:215]
v_mfma_f32_16x16x32_bf16 v[160:163], v[184:187], v[100:103], v[216:219]
v_mfma_f32_16x16x32_bf16 v[164:167], v[184:187], v[104:107], v[220:223]
s_waitcnt lgkmcnt(5)
v_mfma_f32_16x16x32_bf16 v[144:147], v[188:191], v[108:111], v[144:147]
v_mfma_f32_16x16x32_bf16 v[148:151], v[188:191], v[112:115], v[148:151]
v_mfma_f32_16x16x32_bf16 v[152:155], v[188:191], v[116:119], v[152:155]
s_waitcnt lgkmcnt(4)
v_mfma_f32_16x16x32_bf16 v[156:159], v[192:195], v[108:111], v[156:159]
v_mfma_f32_16x16x32_bf16 v[160:163], v[192:195], v[112:115], v[160:163]
v_mfma_f32_16x16x32_bf16 v[164:167], v[192:195], v[116:119], v[164:167]
s_waitcnt lgkmcnt(3)
v_mfma_f32_16x16x32_bf16 v[144:147], v[196:199], v[120:123], v[144:147]
v_mfma_f32_16x16x32_bf16 v[148:151], v[196:199], v[124:127], v[148:151]
v_mfma_f32_16x16x32_bf16 v[152:155], v[196:199], v[128:131], v[152:155]
s_waitcnt lgkmcnt(2)
v_mfma_f32_16x16x32_bf16 v[156:159], v[200:203], v[120:123], v[156:159]
v_mfma_f32_16x16x32_bf16 v[160:163], v[200:203], v[124:127], v[160:163]
v_mfma_f32_16x16x32_bf16 v[164:167], v[200:203], v[128:131], v[164:167]
s_waitcnt lgkmcnt(1)
v_mfma_f32_16x16x32_bf16 v[144:147], v[204:207], v[132:135], v[144:147]
v_mfma_f32_16x16x32_bf16 v[148:151], v[204:207], v[136:139], v[148:151]
v_mfma_f32_16x16x32_bf16 v[152:155], v[204:207], v[140:143], v[152:155]
s_waitcnt lgkmcnt(0)
v_mfma_f32_16x16x32_bf16 v[156:159], v[208:211], v[132:135], v[156:159]
v_mfma_f32_16x16x32_bf16 v[160:163], v[208:211], v[136:139], v[160:163]
v_mfma_f32_16x16x32_bf16 v[164:167], v[208:211], v[140:143], v[164:167]
s_nop 1
v_max3_f32 v227, v144, v145, v146
s_nop 2
v_max3_f32 v227, v227, v147, v156
v_max3_f32 v227, v227, v157, v158
v_max_f32 v227, v227, v159
v_max3_f32 v228, v148, v149, v150
v_max3_f32 v228, v228, v151, v160
v_max3_f32 v228, v228, v161, v162
v_max_f32 v228, v228, v163
v_max3_f32 v229, v152, v153, v154
v_max3_f32 v229, v229, v155, v164
v_max3_f32 v229, v229, v165, v166
v_max_f32 v229, v229, v167
v_mov_b32 v244, v227
v_mov_b32 v245, v228
v_mov_b32 v246, v229
v_permlane32_swap_b32 v227, v244
v_permlane32_swap_b32 v228, v245
v_permlane32_swap_b32 v229, v246
v_max_f32 v227, v227, v244
v_max_f32 v228, v228, v245
v_max_f32 v229, v229, v246
v_mov_b32 v244, v227
v_mov_b32 v245, v228
v_mov_b32 v246, v229
v_permlane16_swap_b32 v227, v244
v_permlane16_swap_b32 v228, v245
v_permlane16_swap_b32 v229, v246
v_max_f32 v227, v227, v244
v_max_f32 v228, v228, v245
v_max_f32 v229, v229, v246
v_max_f32 v227, 0, v227
v_max_f32 v228, 0, v228
v_max_f32 v229, 0, v229
v_sub_f32 v144, v144, v227
v_sub_f32 v145, v145, v227
v_sub_f32 v146, v146, v227
v_sub_f32 v147, v147, v227
v_sub_f32 v156, v156, v227
v_sub_f32 v157, v157, v227
v_sub_f32 v158, v158, v227
v_sub_f32 v159, v159, v227
v_sub_f32 v148, v148, v228
v_sub_f32 v149, v149, v228
v_sub_f32 v150, v150, v228
v_sub_f32 v151, v151, v228
v_sub_f32 v160, v160, v228
v_sub_f32 v161, v161, v228
v_sub_f32 v162, v162, v228
v_sub_f32 v163, v163, v228
v_sub_f32 v152, v152, v229
v_sub_f32 v153, v153, v229
v_sub_f32 v154, v154, v229
v_sub_f32 v155, v155, v229
v_sub_f32 v164, v164, v229
v_sub_f32 v165, v165, v229
v_sub_f32 v166, v166, v229
v_sub_f32 v167, v167, v229
v_sub_f32 v212, v212, v227
v_sub_f32 v213, v213, v227
v_sub_f32 v214, v214, v227
v_sub_f32 v215, v215, v227
v_sub_f32 v244, 0, v227
v_exp_f32 v244, v244
v_sub_f32 v216, v216, v228
v_sub_f32 v217, v217, v228
v_sub_f32 v218, v218, v228
v_sub_f32 v219, v219, v228
v_sub_f32 v245, 0, v228
v_exp_f32 v245, v245
v_sub_f32 v220, v220, v229
v_sub_f32 v221, v221, v229
v_sub_f32 v222, v222, v229
v_sub_f32 v223, v223, v229
v_sub_f32 v246, 0, v229
v_exp_f32 v246, v246
v_mul_f32 v224, v224, v244
v_mul_f32 v0, v0, v244
v_mul_f32 v1, v1, v244
v_mul_f32 v2, v2, v244
v_mul_f32 v3, v3, v244
v_mul_f32 v12, v12, v244
v_mul_f32 v13, v13, v244
v_mul_f32 v14, v14, v244
v_mul_f32 v15, v15, v244
v_mul_f32 v24, v24, v244
v_mul_f32 v25, v25, v244
v_mul_f32 v26, v26, v244
v_mul_f32 v27, v27, v244
v_mul_f32 v36, v36, v244
v_mul_f32 v37, v37, v244
v_mul_f32 v38, v38, v244
v_mul_f32 v39, v39, v244
v_mul_f32 v48, v48, v244
v_mul_f32 v49, v49, v244
v_mul_f32 v50, v50, v244
v_mul_f32 v51, v51, v244
v_mul_f32 v60, v60, v244
v_mul_f32 v61, v61, v244
v_mul_f32 v62, v62, v244
v_mul_f32 v63, v63, v244
v_mul_f32 v72, v72, v244
v_mul_f32 v73, v73, v244
v_mul_f32 v74, v74, v244
v_mul_f32 v75, v75, v244
v_mul_f32 v84, v84, v244
v_mul_f32 v85, v85, v244
v_mul_f32 v86, v86, v244
v_mul_f32 v87, v87, v244
v_mul_f32 v225, v225, v245
v_mul_f32 v4, v4, v245
v_mul_f32 v5, v5, v245
v_mul_f32 v6, v6, v245
v_mul_f32 v7, v7, v245
v_mul_f32 v16, v16, v245
v_mul_f32 v17, v17, v245
v_mul_f32 v18, v18, v245
v_mul_f32 v19, v19, v245
v_mul_f32 v28, v28, v245
v_mul_f32 v29, v29, v245
v_mul_f32 v30, v30, v245
v_mul_f32 v31, v31, v245
v_mul_f32 v40, v40, v245
v_mul_f32 v41, v41, v245
v_mul_f32 v42, v42, v245
v_mul_f32 v43, v43, v245
v_mul_f32 v52, v52, v245
v_mul_f32 v53, v53, v245
v_mul_f32 v54, v54, v245
v_mul_f32 v55, v55, v245
v_mul_f32 v64, v64, v245
v_mul_f32 v65, v65, v245
v_mul_f32 v66, v66, v245
v_mul_f32 v67, v67, v245
v_mul_f32 v76, v76, v245
v_mul_f32 v77, v77, v245
v_mul_f32 v78, v78, v245
v_mul_f32 v79, v79, v245
v_mul_f32 v88, v88, v245
v_mul_f32 v89, v89, v245
v_mul_f32 v90, v90, v245
v_mul_f32 v91, v91, v245
v_mul_f32 v226, v226, v246
v_mul_f32 v8, v8, v246
v_mul_f32 v9, v9, v246
v_mul_f32 v10, v10, v246
v_mul_f32 v11, v11, v246
v_mul_f32 v20, v20, v246
v_mul_f32 v21, v21, v246
v_mul_f32 v22, v22, v246
v_mul_f32 v23, v23, v246
v_mul_f32 v32, v32, v246
v_mul_f32 v33, v33, v246
v_mul_f32 v34, v34, v246
v_mul_f32 v35, v35, v246
v_mul_f32 v44, v44, v246
v_mul_f32 v45, v45, v246
v_mul_f32 v46, v46, v246
v_mul_f32 v47, v47, v246
v_mul_f32 v56, v56, v246
v_mul_f32 v57, v57, v246
v_mul_f32 v58, v58, v246
v_mul_f32 v59, v59, v246
v_mul_f32 v68, v68, v246
v_mul_f32 v69, v69, v246
v_mul_f32 v70, v70, v246
v_mul_f32 v71, v71, v246
v_mul_f32 v80, v80, v246
v_mul_f32 v81, v81, v246
v_mul_f32 v82, v82, v246
v_mul_f32 v83, v83, v246
v_mul_f32 v92, v92, v246
v_mul_f32 v93, v93, v246
v_mul_f32 v94, v94, v246
v_mul_f32 v95, v95, v246
s_nop 1
s_branch SM_R0
START_R1:
s_add_u32 m0, s42, 20992
s_nop 0
buffer_load_dwordx4 v242, s[16:19], s43 offen lds
s_add_u32 m0, s42, 25344
s_add_u32 s38, s43, 131072
buffer_load_dwordx4 v242, s[16:19], s38 offen lds
s_mov_b32 m0, s44
s_nop 0
buffer_load_dwordx4 v243, s[20:23], s45 offen lds
s_add_u32 s43, s43, 262144
s_add_u32 s45, s45, 64
s_add_u32 s46, s46, 1
s_and_b32 s46, s46, 3
s_cmp_eq_u32 s46, 0
s_cselect_b32 s38, s68, s69
s_add_u32 s42, s42, s38
s_add_u32 s44, s44, s38
s_add_u32 m0, s42, 20992
s_nop 0
buffer_load_dwordx4 v242, s[16:19], s43 offen lds
s_add_u32 m0, s42, 25344
s_add_u32 s38, s43, 131072
buffer_load_dwordx4 v242, s[16:19], s38 offen lds
s_mov_b32 m0, s44
s_nop 0
buffer_load_dwordx4 v243, s[20:23], s45 offen lds
s_add_u32 s43, s43, 262144
s_add_u32 s45, s45, 64
s_add_u32 s46, s46, 1
s_and_b32 s46, s46, 3
s_cmp_eq_u32 s46, 0
s_cselect_b32 s38, s68, s69
s_add_u32 s42, s42, s38
s_add_u32 s44, s44, s38
s_add_u32 m0, s42, 20992
s_nop 0
buffer_load_dwordx4 v242, s[16:19], s43 offen lds
s_add_u32 m0, s42, 25344
s_add_u32 s38, s43, 131072
buffer_load_dwordx4 v242, s[16:19], s38 offen lds
s_mov_b32 m0, s44
s_nop 0
buffer_load_dwordx4 v243, s[20:23], s45 offen lds
s_add_u32 s43, s43, 262144
s_add_u32 s45, s45, 64
s_add_u32 s46, s46, 1
s_and_b32 s46, s46, 3
s_cmp_eq_u32 s46, 0
s_cselect_b32 s38, s68, s69
s_add_u32 s42, s42, s38
s_add_u32 s44, s44, s38
v_mov_b32 v0, 0
v_mov_b32 v1, 0
v_mov_b32 v2, 0
v_mov_b32 v3, 0
v_mov_b32 v4, 0
v_mov_b32 v5, 0
v_mov_b32 v6, 0
v_mov_b32 v7, 0
v_mov_b32 v8, 0
v_mov_b32 v9, 0
v_mov_b32 v10, 0
v_mov_b32 v11, 0
v_mov_b32 v12, 0
v_mov_b32 v13, 0
v_mov_b32 v14, 0
v_mov_b32 v15, 0
v_mov_b32 v16, 0
v_mov_b32 v17, 0
v_mov_b32 v18, 0
v_mov_b32 v19, 0
v_mov_b32 v20, 0
v_mov_b32 v21, 0
v_mov_b32 v22, 0
v_mov_b32 v23, 0
v_mov_b32 v24, 0
v_mov_b32 v25, 0
v_mov_b32 v26, 0
v_mov_b32 v27, 0
v_mov_b32 v28, 0
v_mov_b32 v29, 0
v_mov_b32 v30, 0
v_mov_b32 v31, 0
v_mov_b32 v32, 0
v_mov_b32 v33, 0
v_mov_b32 v34, 0
v_mov_b32 v35, 0
v_mov_b32 v36, 0
v_mov_b32 v37, 0
v_mov_b32 v38, 0
v_mov_b32 v39, 0
v_mov_b32 v40, 0
v_mov_b32 v41, 0
v_mov_b32 v42, 0
v_mov_b32 v43, 0
v_mov_b32 v44, 0
v_mov_b32 v45, 0
v_mov_b32 v46, 0
v_mov_b32 v47, 0
v_mov_b32 v48, 0
v_mov_b32 v49, 0
v_mov_b32 v50, 0
v_mov_b32 v51, 0
v_mov_b32 v52, 0
v_mov_b32 v53, 0
v_mov_b32 v54, 0
v_mov_b32 v55, 0
v_mov_b32 v56, 0
v_mov_b32 v57, 0
v_mov_b32 v58, 0
v_mov_b32 v59, 0
v_mov_b32 v60, 0
v_mov_b32 v61, 0
v_mov_b32 v62, 0
v_mov_b32 v63, 0
v_mov_b32 v64, 0
v_mov_b32 v65, 0
v_mov_b32 v66, 0
v_mov_b32 v67, 0
v_mov_b32 v68, 0
v_mov_b32 v69, 0
v_mov_b32 v70, 0
v_mov_b32 v71, 0
v_mov_b32 v72, 0
v_mov_b32 v73, 0
v_mov_b32 v74, 0
v_mov_b32 v75, 0
v_mov_b32 v76, 0
v_mov_b32 v77, 0
v_mov_b32 v78, 0
v_mov_b32 v79, 0
v_mov_b32 v80, 0
v_mov_b32 v81, 0
v_mov_b32 v82, 0
v_mov_b32 v83, 0
v_mov_b32 v84, 0
v_mov_b32 v85, 0
v_mov_b32 v86, 0
v_mov_b32 v87, 0
v_mov_b32 v88, 0
v_mov_b32 v89, 0
v_mov_b32 v90, 0
v_mov_b32 v91, 0
v_mov_b32 v92, 0
v_mov_b32 v93, 0
v_mov_b32 v94, 0
v_mov_b32 v95, 0
s_waitcnt vmcnt(6)
s_barrier
s_setprio 1
ds_read_b128 v[144:147], v241 offset:0
ds_read_b64_tr_b16 v[180:181], v237 offset:0
ds_read_b64_tr_b16 v[182:183], v237 offset:1088
ds_read_b128 v[148:151], v241 offset:1024
ds_read_b128 v[152:155], v241 offset:2048
ds_read_b64_tr_b16 v[184:185], v238 offset:0
ds_read_b64_tr_b16 v[186:187], v238 offset:1088
ds_read_b64_tr_b16 v[188:189], v239 offset:0
ds_read_b64_tr_b16 v[190:191], v239 offset:1088
ds_read_b64_tr_b16 v[192:193], v240 offset:0
ds_read_b64_tr_b16 v[194:195], v240 offset:1088
s_add_u32 m0, s42, 20992
s_nop 0
buffer_load_dwordx4 v242, s[16:19], s43 offen lds
ds_read_b64_tr_b16 v[196:197], v237 offset:128
ds_read_b64_tr_b16 v[198:199], v237 offset:1216
s_add_u32 s47, s47, 1
s_and_b32 s47, s47, 3
s_cmp_eq_u32 s47, 0
s_cselect_b32 s39, s68, s69
s_waitcnt lgkmcnt(10)
v_mfma_f32_16x16x32_bf16 v[0:3], v[180:183], v[144:147], v[0:3]
s_waitcnt lgkmcnt(9)
v_mfma_f32_16x16x32_bf16 v[4:7], v[180:183], v[148:151], v[4:7]
s_waitcnt lgkmcnt(8)
v_mfma_f32_16x16x32_bf16 v[8:11], v[180:183], v[152:155], v[8:11]
ds_read_b64_tr_b16 v[200:201], v238 offset:128
ds_read_b64_tr_b16 v[202:203], v238 offset:1216
s_add_u32 m0, s42, 25344
s_add_u32 s38, s43, 131072
buffer_load_dwordx4 v242, s[16:19], s38 offen lds
s_waitcnt lgkmcnt(8)
v_mfma_f32_16x16x32_bf16 v[12:15], v[184:187], v[144:147], v[12:15]
v_mfma_f32_16x16x32_bf16 v[16:19], v[184:187], v[148:151], v[16:19]
v_mfma_f32_16x16x32_bf16 v[20:23], v[184:187], v[152:155], v[20:23]
ds_read_b64_tr_b16 v[204:205], v239 offset:128
ds_read_b64_tr_b16 v[206:207], v239 offset:1216
s_waitcnt lgkmcnt(8)
v_mfma_f32_16x16x32_bf16 v[24:27], v[188:191], v[144:147], v[24:27]
v_mfma_f32_16x16x32_bf16 v[28:31], v[188:191], v[148:151], v[28:31]
v_mfma_f32_16x16x32_bf16 v[32:35], v[188:191], v[152:155], v[32:35]
ds_read_b64_tr_b16 v[208:209], v240 offset:128
ds_read_b64_tr_b16 v[210:211], v240 offset:1216
s_mov_b32 m0, s44
s_nop 0
buffer_load_dwordx4 v243, s[20:23], s45 offen lds
s_add_u32 s43, s43, 262144
s_add_u32 s45, s45, 64
s_add_u32 s46, s46, 1
s_and_b32 s46, s46, 3
s_cmp_eq_u32 s46, 0
s_cselect_b32 s38, s68, s69
s_add_u32 s42, s42, s38
s_add_u32 s44, s44, s38
s_waitcnt lgkmcnt(8)
v_mfma_f32_16x16x32_bf16 v[36:39], v[192:195], v[144:147], v[36:39]
v_mfma_f32_16x16x32_bf16 v[40:43], v[192:195], v[148:151], v[40:43]
v_mfma_f32_16x16x32_bf16 v[44:47], v[192:195], v[152:155], v[44:47]
v_add_u32 v241, s39, v241
v_add_u32 v237, s39, v237
v_add_u32 v238, s39, v238
v_add_u32 v239, s39, v239
v_add_u32 v240, s39, v240
s_mov_b32 m0, s34
s_nop 0
buffer_load_dwordx4 v235, s[8:11], s32 offen nt lds
s_waitcnt lgkmcnt(6)
v_mfma_f32_16x16x32_bf16 v[48:51], v[196:199], v[144:147], v[48:51]
v_mfma_f32_16x16x32_bf16 v[52:55], v[196:199], v[148:151], v[52:55]
v_mfma_f32_16x16x32_bf16 v[56:59], v[196:199], v[152:155], v[56:59]
s_add_u32 m0, s34, 4352
s_add_u32 s38, s32, 4096
buffer_load_dwordx4 v235, s[8:11], s38 offen nt lds
s_add_u32 s32, s32, 8192
s_add_u32 s48, s48, 1
s_and_b32 s48, s48, 3
s_cmp_eq_u32 s48, 0
s_cselect_b32 s38, s66, s67
s_add_u32 s34, s34, s38
s_mov_b32 m0, s35
s_nop 0
buffer_load_dwordx4 v236, s[12:15], s33 offen nt lds
s_add_u32 m0, s35, 4608
s_add_u32 s38, s33, 4096
buffer_load_dwordx4 v236, s[12:15], s38 offen nt lds
s_add_u32 s33, s33, 8192
s_add_u32 s49, s49, 1
s_and_b32 s49, s49, 3
s_cmp_eq_u32 s49, 0
s_cselect_b32 s38, s66, s67
s_add_u32 s35, s35, s38
s_waitcnt lgkmcnt(0)
s_waitcnt vmcnt(10)
s_barrier
ds_read_b128 v[168:171], v241 offset:0
ds_read_b64_tr_b16 v[180:181], v237 offset:0
ds_read_b64_tr_b16 v[182:183], v237 offset:1088
ds_read_b128 v[172:175], v241 offset:1024
ds_read_b128 v[176:179], v241 offset:2048
ds_read_b64_tr_b16 v[184:185], v238 offset:0
ds_read_b64_tr_b16 v[186:187], v238 offset:1088
v_mfma_f32_16x16x32_bf16 v[60:63], v[200:203], v[144:147], v[60:63]
v_mfma_f32_16x16x32_bf16 v[64:67], v[200:203], v[148:151], v[64:67]
v_mfma_f32_16x16x32_bf16 v[68:71], v[200:203], v[152:155], v[68:71]
ds_read_b64_tr_b16 v[188:189], v239 offset:0
ds_read_b64_tr_b16 v[190:191], v239 offset:1088
v_mfma_f32_16x16x32_bf16 v[72:75], v[204:207], v[144:147], v[72:75]
v_mfma_f32_16x16x32_bf16 v[76:79], v[204:207], v[148:151], v[76:79]
v_mfma_f32_16x16x32_bf16 v[80:83], v[204:207], v[152:155], v[80:83]
ds_read_b64_tr_b16 v[192:193], v240 offset:0
ds_read_b64_tr_b16 v[194:195], v240 offset:1088
s_add_u32 m0, s42, 20992
s_nop 0
buffer_load_dwordx4 v242, s[16:19], s43 offen lds
v_mfma_f32_16x16x32_bf16 v[84:87], v[208:211], v[144:147], v[84:87]
v_mfma_f32_16x16x32_bf16 v[88:91], v[208:211], v[148:151], v[88:91]
v_mfma_f32_16x16x32_bf16 v[92:95], v[208:211], v[152:155], v[92:95]
ds_read_b64_tr_b16 v[196:197], v237 offset:128
ds_read_b64_tr_b16 v[198:199], v237 offset:1216
s_add_u32 s47, s47, 1
s_and_b32 s47, s47, 3
s_cmp_eq_u32 s47, 0
s_cselect_b32 s39, s68, s69
s_waitcnt lgkmcnt(10)
v_mfma_f32_16x16x32_bf16 v[0:3], v[180:183], v[168:171], v[0:3]
s_waitcnt lgkmcnt(9)
v_mfma_f32_16x16x32_bf16 v[4:7], v[180:183], v[172:175], v[4:7]
s_waitcnt lgkmcnt(8)
v_mfma_f32_16x16x32_bf16 v[8:11], v[180:183], v[176:179], v[8:11]
ds_read_b64_tr_b16 v[200:201], v238 offset:128
ds_read_b64_tr_b16 v[202:203], v238 offset:1216
s_add_u32 m0, s42, 25344
s_add_u32 s38, s43, 131072
buffer_load_dwordx4 v242, s[16:19], s38 offen lds
s_waitcnt lgkmcnt(8)
v_mfma_f32_16x16x32_bf16 v[12:15], v[184:187], v[168:171], v[12:15]
v_mfma_f32_16x16x32_bf16 v[16:19], v[184:187], v[172:175], v[16:19]
v_mfma_f32_16x16x32_bf16 v[20:23], v[184:187], v[176:179], v[20:23]
ds_read_b64_tr_b16 v[204:205], v239 offset:128
ds_read_b64_tr_b16 v[206:207], v239 offset:1216
s_waitcnt lgkmcnt(8)
v_mfma_f32_16x16x32_bf16 v[24:27], v[188:191], v[168:171], v[24:27]
v_mfma_f32_16x16x32_bf16 v[28:31], v[188:191], v[172:175], v[28:31]
v_mfma_f32_16x16x32_bf16 v[32:35], v[188:191], v[176:179], v[32:35]
ds_read_b64_tr_b16 v[208:209], v240 offset:128
ds_read_b64_tr_b16 v[210:211], v240 offset:1216
s_mov_b32 m0, s44
s_nop 0
buffer_load_dwordx4 v243, s[20:23], s45 offen lds
s_add_u32 s43, s43, 262144
s_add_u32 s45, s45, 64
s_add_u32 s46, s46, 1
s_and_b32 s46, s46, 3
s_cmp_eq_u32 s46, 0
s_cselect_b32 s38, s68, s69
s_add_u32 s42, s42, s38
s_add_u32 s44, s44, s38
s_waitcnt lgkmcnt(8)
v_mfma_f32_16x16x32_bf16 v[36:39], v[192:195], v[168:171], v[36:39]
v_mfma_f32_16x16x32_bf16 v[40:43], v[192:195], v[172:175], v[40:43]
v_mfma_f32_16x16x32_bf16 v[44:47], v[192:195], v[176:179], v[44:47]
v_add_u32 v241, s39, v241
v_add_u32 v237, s39, v237
v_add_u32 v238, s39, v238
v_add_u32 v239, s39, v239
v_add_u32 v240, s39, v240
s_waitcnt lgkmcnt(6)
v_mfma_f32_16x16x32_bf16 v[48:51], v[196:199], v[168:171], v[48:51]
v_mfma_f32_16x16x32_bf16 v[52:55], v[196:199], v[172:175], v[52:55]
v_mfma_f32_16x16x32_bf16 v[56:59], v[196:199], v[176:179], v[56:59]
s_waitcnt lgkmcnt(0)
s_waitcnt vmcnt(10)
s_barrier
ds_read_b128 v[144:147], v241 offset:0
ds_read_b64_tr_b16 v[180:181], v237 offset:0
ds_read_b64_tr_b16 v[182:183], v237 offset:1088
ds_read_b128 v[148:151], v241 offset:1024
ds_read_b128 v[152:155], v241 offset:2048
ds_read_b64_tr_b16 v[184:185], v238 offset:0
ds_read_b64_tr_b16 v[186:187], v238 offset:1088
v_mfma_f32_16x16x32_bf16 v[60:63], v[200:203], v[168:171], v[60:63]
v_mfma_f32_16x16x32_bf16 v[64:67], v[200:203], v[172:175], v[64:67]
v_mfma_f32_16x16x32_bf16 v[68:71], v[200:203], v[176:179], v[68:71]
ds_read_b64_tr_b16 v[188:189], v239 offset:0
ds_read_b64_tr_b16 v[190:191], v239 offset:1088
v_mfma_f32_16x16x32_bf16 v[72:75], v[204:207], v[168:171], v[72:75]
v_mfma_f32_16x16x32_bf16 v[76:79], v[204:207], v[172:175], v[76:79]
v_mfma_f32_16x16x32_bf16 v[80:83], v[204:207], v[176:179], v[80:83]
ds_read_b64_tr_b16 v[192:193], v240 offset:0
ds_read_b64_tr_b16 v[194:195], v240 offset:1088
s_add_u32 m0, s42, 20992
s_nop 0
buffer_load_dwordx4 v242, s[16:19], s43 offen lds
v_mfma_f32_16x16x32_bf16 v[84:87], v[208:211], v[168:171], v[84:87]
v_mfma_f32_16x16x32_bf16 v[88:91], v[208:211], v[172:175], v[88:91]
v_mfma_f32_16x16x32_bf16 v[92:95], v[208:211], v[176:179], v[92:95]
ds_read_b64_tr_b16 v[196:197], v237 offset:128
ds_read_b64_tr_b16 v[198:199], v237 offset:1216
s_add_u32 s47, s47, 1
s_and_b32 s47, s47, 3
s_cmp_eq_u32 s47, 0
s_cselect_b32 s39, s68, s69
s_waitcnt lgkmcnt(10)
v_mfma_f32_16x16x32_bf16 v[0:3], v[180:183], v[144:147], v[0:3]
s_waitcnt lgkmcnt(9)
v_mfma_f32_16x16x32_bf16 v[4:7], v[180:183], v[148:151], v[4:7]
s_waitcnt lgkmcnt(8)
v_mfma_f32_16x16x32_bf16 v[8:11], v[180:183], v[152:155], v[8:11]
ds_read_b64_tr_b16 v[200:201], v238 offset:128
ds_read_b64_tr_b16 v[202:203], v238 offset:1216
s_add_u32 m0, s42, 25344
s_add_u32 s38, s43, 131072
buffer_load_dwordx4 v242, s[16:19], s38 offen lds
s_waitcnt lgkmcnt(8)
v_mfma_f32_16x16x32_bf16 v[12:15], v[184:187], v[144:147], v[12:15]
v_mfma_f32_16x16x32_bf16 v[16:19], v[184:187], v[148:151], v[16:19]
v_mfma_f32_16x16x32_bf16 v[20:23], v[184:187], v[152:155], v[20:23]
ds_read_b64_tr_b16 v[204:205], v239 offset:128
ds_read_b64_tr_b16 v[206:207], v239 offset:1216
s_waitcnt lgkmcnt(8)
v_mfma_f32_16x16x32_bf16 v[24:27], v[188:191], v[144:147], v[24:27]
v_mfma_f32_16x16x32_bf16 v[28:31], v[188:191], v[148:151], v[28:31]
v_mfma_f32_16x16x32_bf16 v[32:35], v[188:191], v[152:155], v[32:35]
ds_read_b64_tr_b16 v[208:209], v240 offset:128
ds_read_b64_tr_b16 v[210:211], v240 offset:1216
s_mov_b32 m0, s44
s_nop 0
buffer_load_dwordx4 v243, s[20:23], s45 offen lds
s_add_u32 s43, s43, 262144
s_add_u32 s45, s45, 64
s_add_u32 s46, s46, 1
s_and_b32 s46, s46, 3
s_cmp_eq_u32 s46, 0
s_cselect_b32 s38, s68, s69
s_add_u32 s42, s42, s38
s_add_u32 s44, s44, s38
s_waitcnt lgkmcnt(8)
v_mfma_f32_16x16x32_bf16 v[36:39], v[192:195], v[144:147], v[36:39]
v_mfma_f32_16x16x32_bf16 v[40:43], v[192:195], v[148:151], v[40:43]
v_mfma_f32_16x16x32_bf16 v[44:47], v[192:195], v[152:155], v[44:47]
v_add_u32 v241, s39, v241
v_add_u32 v237, s39, v237
v_add_u32 v238, s39, v238
v_add_u32 v239, s39, v239
v_add_u32 v240, s39, v240
s_waitcnt lgkmcnt(6)
v_mfma_f32_16x16x32_bf16 v[48:51], v[196:199], v[144:147], v[48:51]
v_mfma_f32_16x16x32_bf16 v[52:55], v[196:199], v[148:151], v[52:55]
v_mfma_f32_16x16x32_bf16 v[56:59], v[196:199], v[152:155], v[56:59]
s_waitcnt lgkmcnt(0)
s_waitcnt vmcnt(10)
s_barrier
s_mov_b32 s31, 3
QL_R1:
ds_read_b128 v[168:171], v241 offset:0
ds_read_b64_tr_b16 v[180:181], v237 offset:0
ds_read_b64_tr_b16 v[182:183], v237 offset:1088
ds_read_b128 v[172:175], v241 offset:1024
ds_read_b128 v[176:179], v241 offset:2048
ds_read_b64_tr_b16 v[184:185], v238 offset:0
ds_read_b64_tr_b16 v[186:187], v238 offset:1088
v_mfma_f32_16x16x32_bf16 v[60:63], v[200:203], v[144:147], v[60:63]
v_mfma_f32_16x16x32_bf16 v[64:67], v[200:203], v[148:151], v[64:67]
v_mfma_f32_16x16x32_bf16 v[68:71], v[200:203], v[152:155], v[68:71]
ds_read_b64_tr_b16 v[188:189], v239 offset:0
ds_read_b64_tr_b16 v[190:191], v239 offset:1088
v_mfma_f32_16x16x32_bf16 v[72:75], v[204:207], v[144:147], v[72:75]
v_mfma_f32_16x16x32_bf16 v[76:79], v[204:207], v[148:151], v[76:79]
v_mfma_f32_16x16x32_bf16 v[80:83], v[204:207], v[152:155], v[80:83]
ds_read_b64_tr_b16 v[192:193], v240 offset:0
ds_read_b64_tr_b16 v[194:195], v240 offset:1088
s_add_u32 m0, s42, 20992
s_nop 0
buffer_load_dwordx4 v242, s[16:19], s43 offen lds
v_mfma_f32_16x16x32_bf16 v[84:87], v[208:211], v[144:147], v[84:87]
v_mfma_f32_16x16x32_bf16 v[88:91], v[208:211], v[148:151], v[88:91]
v_mfma_f32_16x16x32_bf16 v[92:95], v[208:211], v[152:155], v[92:95]
ds_read_b64_tr_b16 v[196:197], v237 offset:128
ds_read_b64_tr_b16 v[198:199], v237 offset:1216
s_add_u32 s47, s47, 1
s_and_b32 s47, s47, 3
s_cmp_eq_u32 s47, 0
s_cselect_b32 s39, s68, s69
s_waitcnt lgkmcnt(10)
v_mfma_f32_16x16x32_bf16 v[0:3], v[180:183], v[168:171], v[0:3]
s_waitcnt lgkmcnt(9)
v_mfma_f32_16x16x32_bf16 v[4:7], v[180:183], v[172:175], v[4:7]
s_waitcnt lgkmcnt(8)
v_mfma_f32_16x16x32_bf16 v[8:11], v[180:183], v[176:179], v[8:11]
ds_read_b64_tr_b16 v[200:201], v238 offset:128
ds_read_b64_tr_b16 v[202:203], v238 offset:1216
s_add_u32 m0, s42, 25344
s_add_u32 s38, s43, 131072
buffer_load_dwordx4 v242, s[16:19], s38 offen lds
s_waitcnt lgkmcnt(8)
v_mfma_f32_16x16x32_bf16 v[12:15], v[184:187], v[168:171], v[12:15]
v_mfma_f32_16x16x32_bf16 v[16:19], v[184:187], v[172:175], v[16:19]
v_mfma_f32_16x16x32_bf16 v[20:23], v[184:187], v[176:179], v[20:23]
ds_read_b64_tr_b16 v[204:205], v239 offset:128
ds_read_b64_tr_b16 v[206:207], v239 offset:1216
s_waitcnt lgkmcnt(8)
v_mfma_f32_16x16x32_bf16 v[24:27], v[188:191], v[168:171], v[24:27]
v_mfma_f32_16x16x32_bf16 v[28:31], v[188:191], v[172:175], v[28:31]
v_mfma_f32_16x16x32_bf16 v[32:35], v[188:191], v[176:179], v[32:35]
ds_read_b64_tr_b16 v[208:209], v240 offset:128
ds_read_b64_tr_b16 v[210:211], v240 offset:1216
s_mov_b32 m0, s44
s_nop 0
buffer_load_dwordx4 v243, s[20:23], s45 offen lds
s_add_u32 s43, s43, 262144
s_add_u32 s45, s45, 64
s_add_u32 s46, s46, 1
s_and_b32 s46, s46, 3
s_cmp_eq_u32 s46, 0
s_cselect_b32 s38, s68, s69
s_add_u32 s42, s42, s38
s_add_u32 s44, s44, s38
s_waitcnt lgkmcnt(8)
v_mfma_f32_16x16x32_bf16 v[36:39], v[192:195], v[168:171], v[36:39]
v_mfma_f32_16x16x32_bf16 v[40:43], v[192:195], v[172:175], v[40:43]
v_mfma_f32_16x16x32_bf16 v[44:47], v[192:195], v[176:179], v[44:47]
v_add_u32 v241, s39, v241
v_add_u32 v237, s39, v237
v_add_u32 v238, s39, v238
v_add_u32 v239, s39, v239
v_add_u32 v240, s39, v240
s_waitcnt lgkmcnt(6)
v_mfma_f32_16x16x32_bf16 v[48:51], v[196:199], v[168:171], v[48:51]
v_mfma_f32_16x16x32_bf16 v[52:55], v[196:199], v[172:175], v[52:55]
v_mfma_f32_16x16x32_bf16 v[56:59], v[196:199], v[176:179], v[56:59]
s_waitcnt lgkmcnt(0)
s_waitcnt vmcnt(6)
s_barrier
s_add_u32 s31, s31, 1
ds_read_b128 v[144:147], v241 offset:0
ds_read_b64_tr_b16 v[180:181], v237 offset:0
ds_read_b64_tr_b16 v[182:183], v237 offset:1088
ds_read_b128 v[148:151], v241 offset:1024
ds_read_b128 v[152:155], v241 offset:2048
ds_read_b64_tr_b16 v[184:185], v238 offset:0
ds_read_b64_tr_b16 v[186:187], v238 offset:1088
v_mfma_f32_16x16x32_bf16 v[60:63], v[200:203], v[168:171], v[60:63]
v_mfma_f32_16x16x32_bf16 v[64:67], v[200:203], v[172:175], v[64:67]
v_mfma_f32_16x16x32_bf16 v[68:71], v[200:203], v[176:179], v[68:71]
ds_read_b64_tr_b16 v[188:189], v239 offset:0
ds_read_b64_tr_b16 v[190:191], v239 offset:1088
v_mfma_f32_16x16x32_bf16 v[72:75], v[204:207], v[168:171], v[72:75]
v_mfma_f32_16x16x32_bf16 v[76:79], v[204:207], v[172:175], v[76:79]
v_mfma_f32_16x16x32_bf16 v[80:83], v[204:207], v[176:179], v[80:83]
ds_read_b64_tr_b16 v[192:193], v240 offset:0
ds_read_b64_tr_b16 v[194:195], v240 offset:1088
s_add_u32 m0, s42, 20992
s_nop 0
buffer_load_dwordx4 v242, s[16:19], s43 offen lds
v_mfma_f32_16x16x32_bf16 v[84:87], v[208:211], v[168:171], v[84:87]
v_mfma_f32_16x16x32_bf16 v[88:91], v[208:211], v[172:175], v[88:91]
v_mfma_f32_16x16x32_bf16 v[92:95], v[208:211], v[176:179], v[92:95]
ds_read_b64_tr_b16 v[196:197], v237 offset:128
ds_read_b64_tr_b16 v[198:199], v237 offset:1216
s_add_u32 s47, s47, 1
s_and_b32 s47, s47, 3
s_cmp_eq_u32 s47, 0
s_cselect_b32 s39, s68, s69
s_waitcnt lgkmcnt(10)
v_mfma_f32_16x16x32_bf16 v[0:3], v[180:183], v[144:147], v[0:3]
s_waitcnt lgkmcnt(9)
v_mfma_f32_16x16x32_bf16 v[4:7], v[180:183], v[148:151], v[4:7]
s_waitcnt lgkmcnt(8)
v_mfma_f32_16x16x32_bf16 v[8:11], v[180:183], v[152:155], v[8:11]
ds_read_b64_tr_b16 v[200:201], v238 offset:128
ds_read_b64_tr_b16 v[202:203], v238 offset:1216
s_add_u32 m0, s42, 25344
s_add_u32 s38, s43, 131072
buffer_load_dwordx4 v242, s[16:19], s38 offen lds
s_waitcnt lgkmcnt(8)
v_mfma_f32_16x16x32_bf16 v[12:15], v[184:187], v[144:147], v[12:15]
v_mfma_f32_16x16x32_bf16 v[16:19], v[184:187], v[148:151], v[16:19]
v_mfma_f32_16x16x32_bf16 v[20:23], v[184:187], v[152:155], v[20:23]
ds_read_b64_tr_b16 v[204:205], v239 offset:128
ds_read_b64_tr_b16 v[206:207], v239 offset:1216
s_waitcnt lgkmcnt(8)
v_mfma_f32_16x16x32_bf16 v[24:27], v[188:191], v[144:147], v[24:27]
v_mfma_f32_16x16x32_bf16 v[28:31], v[188:191], v[148:151], v[28:31]
v_mfma_f32_16x16x32_bf16 v[32:35], v[188:191], v[152:155], v[32:35]
ds_read_b64_tr_b16 v[208:209], v240 offset:128
ds_read_b64_tr_b16 v[210:211], v240 offset:1216
s_mov_b32 m0, s44
s_nop 0
buffer_load_dwordx4 v243, s[20:23], s45 offen lds
s_add_u32 s43, s43, 262144
s_add_u32 s45, s45, 64
s_add_u32 s46, s46, 1
s_and_b32 s46, s46, 3
s_cmp_eq_u32 s46, 0
s_cselect_b32 s38, s68, s69
s_add_u32 s42, s42, s38
s_add_u32 s44, s44, s38
s_waitcnt lgkmcnt(8)
v_mfma_f32_16x16x32_bf16 v[36:39], v[192:195], v[144:147], v[36:39]
v_mfma_f32_16x16x32_bf16 v[40:43], v[192:195], v[148:151], v[40:43]
v_mfma_f32_16x16x32_bf16 v[44:47], v[192:195], v[152:155], v[44:47]
v_add_u32 v241, s39, v241
v_add_u32 v237, s39, v237
v_add_u32 v238, s39, v238
v_add_u32 v239, s39, v239
v_add_u32 v240, s39, v240
s_waitcnt lgkmcnt(6)
v_mfma_f32_16x16x32_bf16 v[48:51], v[196:199], v[144:147], v[48:51]
v_mfma_f32_16x16x32_bf16 v[52:55], v[196:199], v[148:151], v[52:55]
v_mfma_f32_16x16x32_bf16 v[56:59], v[196:199], v[152:155], v[56:59]
s_waitcnt lgkmcnt(0)
s_waitcnt vmcnt(6)
s_barrier
s_add_u32 s31, s31, 1
s_cmp_lt_u32 s31, 13
s_cbranch_scc1 QL_R1
ds_read_b128 v[168:171], v241 offset:0
ds_read_b64_tr_b16 v[180:181], v237 offset:0
ds_read_b64_tr_b16 v[182:183], v237 offset:1088
ds_read_b128 v[172:175], v241 offset:1024
ds_read_b128 v[176:179], v241 offset:2048
ds_read_b64_tr_b16 v[184:185], v238 offset:0
ds_read_b64_tr_b16 v[186:187], v238 offset:1088
v_mfma_f32_16x16x32_bf16 v[60:63], v[200:203], v[144:147], v[60:63]
v_mfma_f32_16x16x32_bf16 v[64:67], v[200:203], v[148:151], v[64:67]
v_mfma_f32_16x16x32_bf16 v[68:71], v[200:203], v[152:155], v[68:71]
ds_read_b64_tr_b16 v[188:189], v239 offset:0
ds_read_b64_tr_b16 v[190:191], v239 offset:1088
v_mfma_f32_16x16x32_bf16 v[72:75], v[204:207], v[144:147], v[72:75]
v_mfma_f32_16x16x32_bf16 v[76:79], v[204:207], v[148:151], v[76:79]
v_mfma_f32_16x16x32_bf16 v[80:83], v[204:207], v[152:155], v[80:83]
ds_read_b64_tr_b16 v[192:193], v240 offset:0
ds_read_b64_tr_b16 v[194:195], v240 offset:1088
s_mov_b32 m0, s34
s_nop 0
buffer_load_dwordx4 v235, s[8:11], s32 offen nt lds
v_mfma_f32_16x16x32_bf16 v[84:87], v[208:211], v[144:147], v[84:87]
v_mfma_f32_16x16x32_bf16 v[88:91], v[208:211], v[148:151], v[88:91]
v_mfma_f32_16x16x32_bf16 v[92:95], v[208:211], v[152:155], v[92:95]
ds_read_b64_tr_b16 v[196:197], v237 offset:128
ds_read_b64_tr_b16 v[198:199], v237 offset:1216
s_add_u32 s47, s47, 1
s_and_b32 s47, s47, 3
s_cmp_eq_u32 s47, 0
s_cselect_b32 s39, s68, s69
s_waitcnt lgkmcnt(10)
v_mfma_f32_16x16x32_bf16 v[0:3], v[180:183], v[168:171], v[0:3]
s_waitcnt lgkmcnt(9)
v_mfma_f32_16x16x32_bf16 v[4:7], v[180:183], v[172:175], v[4:7]
s_waitcnt lgkmcnt(8)
v_mfma_f32_16x16x32_bf16 v[8:11], v[180:183], v[176:179], v[8:11]
ds_read_b64_tr_b16 v[200:201], v238 offset:128
ds_read_b64_tr_b16 v[202:203], v238 offset:1216
s_add_u32 m0, s34, 4352
s_add_u32 s38, s32, 4096
buffer_load_dwordx4 v235, s[8:11], s38 offen nt lds
s_add_u32 s32, s32, 8192
s_add_u32 s48, s48, 1
s_and_b32 s48, s48, 3
s_cmp_eq_u32 s48, 0
s_cselect_b32 s38, s66, s67
s_add_u32 s34, s34, s38
s_waitcnt lgkmcnt(8)
v_mfma_f32_16x16x32_bf16 v[12:15], v[184:187], v[168:171], v[12:15]
v_mfma_f32_16x16x32_bf16 v[16:19], v[184:187], v[172:175], v[16:19]
v_mfma_f32_16x16x32_bf16 v[20:23], v[184:187], v[176:179], v[20:23]
ds_read_b64_tr_b16 v[204:205], v239 offset:128
ds_read_b64_tr_b16 v[206:207], v239 offset:1216
s_waitcnt lgkmcnt(8)
v_mfma_f32_16x16x32_bf16 v[24:27], v[188:191], v[168:171], v[24:27]
v_mfma_f32_16x16x32_bf16 v[28:31], v[188:191], v[172:175], v[28:31]
v_mfma_f32_16x16x32_bf16 v[32:35], v[188:191], v[176:179], v[32:35]
ds_read_b64_tr_b16 v[208:209], v240 offset:128
ds_read_b64_tr_b16 v[210:211], v240 offset:1216
s_mov_b32 m0, s35
s_nop 0
buffer_load_dwordx4 v236, s[12:15], s33 offen nt lds
s_waitcnt lgkmcnt(8)
v_mfma_f32_16x16x32_bf16 v[36:39], v[192:195], v[168:171], v[36:39]
v_mfma_f32_16x16x32_bf16 v[40:43], v[192:195], v[172:175], v[40:43]
v_mfma_f32_16x16x32_bf16 v[44:47], v[192:195], v[176:179], v[44:47]
v_add_u32 v241, s39, v241
v_add_u32 v237, s39, v237
v_add_u32 v238, s39, v238
v_add_u32 v239, s39, v239
v_add_u32 v240, s39, v240
s_add_u32 m0, s35, 4608
s_add_u32 s38, s33, 4096
buffer_load_dwordx4 v236, s[12:15], s38 offen nt lds
s_add_u32 s33, s33, 8192
s_add_u32 s49, s49, 1
s_and_b32 s49, s49, 3
s_cmp_eq_u32 s49, 0
s_cselect_b32 s38, s66, s67
s_add_u32 s35, s35, s38
s_waitcnt lgkmcnt(6)
v_mfma_f32_16x16x32_bf16 v[48:51], v[196:199], v[168:171], v[48:51]
v_mfma_f32_16x16x32_bf16 v[52:55], v[196:199], v[172:175], v[52:55]
v_mfma_f32_16x16x32_bf16 v[56:59], v[196:199], v[176:179], v[56:59]
s_waitcnt lgkmcnt(0)
s_waitcnt vmcnt(6)
s_barrier
ds_read_b128 v[144:147], v241 offset:0
ds_read_b64_tr_b16 v[180:181], v237 offset:0
ds_read_b64_tr_b16 v[182:183], v237 offset:1088
ds_read_b128 v[148:151], v241 offset:1024
ds_read_b128 v[152:155], v241 offset:2048
ds_read_b64_tr_b16 v[184:185], v238 offset:0
ds_read_b64_tr_b16 v[186:187], v238 offset:1088
v_mfma_f32_16x16x32_bf16 v[60:63], v[200:203], v[168:171], v[60:63]
v_mfma_f32_16x16x32_bf16 v[64:67], v[200:203], v[172:175], v[64:67]
v_mfma_f32_16x16x32_bf16 v[68:71], v[200:203], v[176:179], v[68:71]
ds_read_b64_tr_b16 v[188:189], v239 offset:0
ds_read_b64_tr_b16 v[190:191], v239 offset:1088
v_mfma_f32_16x16x32_bf16 v[72:75], v[204:207], v[168:171], v[72:75]
v_mfma_f32_16x16x32_bf16 v[76:79], v[204:207], v[172:175], v[76:79]
v_mfma_f32_16x16x32_bf16 v[80:83], v[204:207], v[176:179], v[80:83]
ds_read_b64_tr_b16 v[192:193], v240 offset:0
ds_read_b64_tr_b16 v[194:195], v240 offset:1088
v_mfma_f32_16x16x32_bf16 v[84:87], v[208:211], v[168:171], v[84:87]
v_mfma_f32_16x16x32_bf16 v[88:91], v[208:211], v[172:175], v[88:91]
v_mfma_f32_16x16x32_bf16 v[92:95], v[208:211], v[176:179], v[92:95]
ds_read_b64_tr_b16 v[196:197], v237 offset:128
ds_read_b64_tr_b16 v[198:199], v237 offset:1216
s_add_u32 s47, s47, 1
s_and_b32 s47, s47, 3
s_cmp_eq_u32 s47, 0
s_cselect_b32 s39, s68, s69
s_waitcnt lgkmcnt(10)
v_mfma_f32_16x16x32_bf16 v[0:3], v[180:183], v[144:147], v[0:3]
s_waitcnt lgkmcnt(9)
v_mfma_f32_16x16x32_bf16 v[4:7], v[180:183], v[148:151], v[4:7]
s_waitcnt lgkmcnt(8)
v_mfma_f32_16x16x32_bf16 v[8:11], v[180:183], v[152:155], v[8:11]
ds_read_b64_tr_b16 v[200:201], v238 offset:128
ds_read_b64_tr_b16 v[202:203], v238 offset:1216
s_waitcnt lgkmcnt(8)
v_mfma_f32_16x16x32_bf16 v[12:15], v[184:187], v[144:147], v[12:15]
v_mfma_f32_16x16x32_bf16 v[16:19], v[184:187], v[148:151], v[16:19]
v_mfma_f32_16x16x32_bf16 v[20:23], v[184:187], v[152:155], v[20:23]
ds_read_b64_tr_b16 v[204:205], v239 offset:128
ds_read_b64_tr_b16 v[206:207], v239 offset:1216
s_waitcnt lgkmcnt(8)
v_mfma_f32_16x16x32_bf16 v[24:27], v[188:191], v[144:147], v[24:27]
v_mfma_f32_16x16x32_bf16 v[28:31], v[188:191], v[148:151], v[28:31]
v_mfma_f32_16x16x32_bf16 v[32:35], v[188:191], v[152:155], v[32:35]
ds_read_b64_tr_b16 v[208:209], v240 offset:128
ds_read_b64_tr_b16 v[210:211], v240 offset:1216
s_waitcnt lgkmcnt(8)
v_mfma_f32_16x16x32_bf16 v[36:39], v[192:195], v[144:147], v[36:39]
v_mfma_f32_16x16x32_bf16 v[40:43], v[192:195], v[148:151], v[40:43]
v_mfma_f32_16x16x32_bf16 v[44:47], v[192:195], v[152:155], v[44:47]
v_add_u32 v241, s39, v241
v_add_u32 v237, s39, v237
v_add_u32 v238, s39, v238
v_add_u32 v239, s39, v239
v_add_u32 v240, s39, v240
s_waitcnt lgkmcnt(6)
v_mfma_f32_16x16x32_bf16 v[48:51], v[196:199], v[144:147], v[48:51]
v_mfma_f32_16x16x32_bf16 v[52:55], v[196:199], v[148:151], v[52:55]
v_mfma_f32_16x16x32_bf16 v[56:59], v[196:199], v[152:155], v[56:59]
s_waitcnt lgkmcnt(0)
s_waitcnt vmcnt(4)
s_barrier
ds_read_b128 v[168:171], v241 offset:0
ds_read_b64_tr_b16 v[180:181], v237 offset:0
ds_read_b64_tr_b16 v[182:183], v237 offset:1088
ds_read_b128 v[172:175], v241 offset:1024
ds_read_b128 v[176:179], v241 offset:2048
ds_read_b64_tr_b16 v[184:185], v238 offset:0
ds_read_b64_tr_b16 v[186:187], v238 offset:1088
v_mfma_f32_16x16x32_bf16 v[60:63], v[200:203], v[144:147], v[60:63]
v_mfma_f32_16x16x32_bf16 v[64:67], v[200:203], v[148:151], v[64:67]
v_mfma_f32_16x16x32_bf16 v[68:71], v[200:203], v[152:155], v[68:71]
ds_read_b64_tr_b16 v[188:189], v239 offset:0
ds_read_b64_tr_b16 v[190:191], v239 offset:1088
v_mfma_f32_16x16x32_bf16 v[72:75], v[204:207], v[144:147], v[72:75]
v_mfma_f32_16x16x32_bf16 v[76:79], v[204:207], v[148:151], v[76:79]
v_mfma_f32_16x16x32_bf16 v[80:83], v[204:207], v[152:155], v[80:83]
ds_read_b64_tr_b16 v[192:193], v240 offset:0
ds_read_b64_tr_b16 v[194:195], v240 offset:1088
s_mov_b32 m0, s34
s_nop 0
buffer_load_dwordx4 v235, s[8:11], s32 offen nt lds
v_mfma_f32_16x16x32_bf16 v[84:87], v[208:211], v[144:147], v[84:87]
v_mfma_f32_16x16x32_bf16 v[88:91], v[208:211], v[148:151], v[88:91]
v_mfma_f32_16x16x32_bf16 v[92:95], v[208:211], v[152:155], v[92:95]
ds_read_b64_tr_b16 v[196:197], v237 offset:128
ds_read_b64_tr_b16 v[198:199], v237 offset:1216
s_add_u32 s47, s47, 1
s_and_b32 s47, s47, 3
s_cmp_eq_u32 s47, 0
s_cselect_b32 s39, s68, s69
s_waitcnt lgkmcnt(10)
v_mfma_f32_16x16x32_bf16 v[0:3], v[180:183], v[168:171], v[0:3]
s_waitcnt lgkmcnt(9)
v_mfma_f32_16x16x32_bf16 v[4:7], v[180:183], v[172:175], v[4:7]
s_waitcnt lgkmcnt(8)
v_mfma_f32_16x16x32_bf16 v[8:11], v[180:183], v[176:179], v[8:11]
ds_read_b64_tr_b16 v[200:201], v238 offset:128
ds_read_b64_tr_b16 v[202:203], v238 offset:1216
s_add_u32 m0, s34, 4352
s_add_u32 s38, s32, 4096
buffer_load_dwordx4 v235, s[8:11], s38 offen nt lds
s_add_u32 s32, s32, 8192
s_add_u32 s48, s48, 1
s_and_b32 s48, s48, 3
s_cmp_eq_u32 s48, 0
s_cselect_b32 s38, s66, s67
s_add_u32 s34, s34, s38
s_waitcnt lgkmcnt(8)
v_mfma_f32_16x16x32_bf16 v[12:15], v[184:187], v[168:171], v[12:15]
v_mfma_f32_16x16x32_bf16 v[16:19], v[184:187], v[172:175], v[16:19]
v_mfma_f32_16x16x32_bf16 v[20:23], v[184:187], v[176:179], v[20:23]
ds_read_b64_tr_b16 v[204:205], v239 offset:128
ds_read_b64_tr_b16 v[206:207], v239 offset:1216
s_waitcnt lgkmcnt(8)
v_mfma_f32_16x16x32_bf16 v[24:27], v[188:191], v[168:171], v[24:27]
v_mfma_f32_16x16x32_bf16 v[28:31], v[188:191], v[172:175], v[28:31]
v_mfma_f32_16x16x32_bf16 v[32:35], v[188:191], v[176:179], v[32:35]
ds_read_b64_tr_b16 v[208:209], v240 offset:128
ds_read_b64_tr_b16 v[210:211], v240 offset:1216
s_waitcnt lgkmcnt(8)
v_mfma_f32_16x16x32_bf16 v[36:39], v[192:195], v[168:171], v[36:39]
v_mfma_f32_16x16x32_bf16 v[40:43], v[192:195], v[172:175], v[40:43]
v_mfma_f32_16x16x32_bf16 v[44:47], v[192:195], v[176:179], v[44:47]
v_add_u32 v241, s39, v241
v_add_u32 v237, s39, v237
v_add_u32 v238, s39, v238
v_add_u32 v239, s39, v239
v_add_u32 v240, s39, v240
s_waitcnt lgkmcnt(6)
v_mfma_f32_16x16x32_bf16 v[48:51], v[196:199], v[168:171], v[48:51]
v_mfma_f32_16x16x32_bf16 v[52:55], v[196:199], v[172:175], v[52:55]
v_mfma_f32_16x16x32_bf16 v[56:59], v[196:199], v[176:179], v[56:59]
s_waitcnt lgkmcnt(0)
s_barrier
v_mfma_f32_16x16x32_bf16 v[60:63], v[200:203], v[168:171], v[60:63]
v_mfma_f32_16x16x32_bf16 v[64:67], v[200:203], v[172:175], v[64:67]
v_mfma_f32_16x16x32_bf16 v[68:71], v[200:203], v[176:179], v[68:71]
v_mfma_f32_16x16x32_bf16 v[72:75], v[204:207], v[168:171], v[72:75]
v_mfma_f32_16x16x32_bf16 v[76:79], v[204:207], v[172:175], v[76:79]
v_mfma_f32_16x16x32_bf16 v[80:83], v[204:207], v[176:179], v[80:83]
v_mfma_f32_16x16x32_bf16 v[84:87], v[208:211], v[168:171], v[84:87]
v_mfma_f32_16x16x32_bf16 v[88:91], v[208:211], v[172:175], v[88:91]
v_mfma_f32_16x16x32_bf16 v[92:95], v[208:211], v[176:179], v[92:95]
s_setprio 0
s_nop 6
s_mov_b32 s38, 0x3e0293ee
s_mov_b32 s39, 0x3e0293ee
v_pk_mul_f32 v[0:1], v[0:1], s[38:39]
v_pk_mul_f32 v[2:3], v[2:3], s[38:39]
v_cvt_pk_bf16_f32 v96, v0, v1
v_cvt_pk_bf16_f32 v97, v2, v3
v_pk_mul_f32 v[12:13], v[12:13], s[38:39]
v_pk_mul_f32 v[14:15], v[14:15], s[38:39]
v_cvt_pk_bf16_f32 v98, v12, v13
v_cvt_pk_bf16_f32 v99, v14, v15
s_nop 0
v_permlane32_swap_b32 v96, v98
v_permlane32_swap_b32 v97, v99
s_nop 0
v_permlane16_swap_b32 v96, v98
v_permlane16_swap_b32 v97, v99
v_pk_mul_f32 v[4:5], v[4:5], s[38:39]
v_pk_mul_f32 v[6:7], v[6:7], s[38:39]
v_cvt_pk_bf16_f32 v100, v4, v5
v_cvt_pk_bf16_f32 v101, v6, v7
v_pk_mul_f32 v[16:17], v[16:17], s[38:39]
v_pk_mul_f32 v[18:19], v[18:19], s[38:39]
v_cvt_pk_bf16_f32 v102, v16, v17
v_cvt_pk_bf16_f32 v103, v18, v19
s_nop 0
v_permlane32_swap_b32 v100, v102
v_permlane32_swap_b32 v101, v103
s_nop 0
v_permlane16_swap_b32 v100, v102
v_permlane16_swap_b32 v101, v103
v_pk_mul_f32 v[8:9], v[8:9], s[38:39]
v_pk_mul_f32 v[10:11], v[10:11], s[38:39]
v_cvt_pk_bf16_f32 v104, v8, v9
v_cvt_pk_bf16_f32 v105, v10, v11
v_pk_mul_f32 v[20:21], v[20:21], s[38:39]
v_pk_mul_f32 v[22:23], v[22:23], s[38:39]
v_cvt_pk_bf16_f32 v106, v20, v21
v_cvt_pk_bf16_f32 v107, v22, v23
s_nop 0
v_permlane32_swap_b32 v104, v106
v_permlane32_swap_b32 v105, v107
s_nop 0
v_permlane16_swap_b32 v104, v106
v_permlane16_swap_b32 v105, v107
v_pk_mul_f32 v[24:25], v[24:25], s[38:39]
v_pk_mul_f32 v[26:27], v[26:27], s[38:39]
v_cvt_pk_bf16_f32 v108, v24, v25
v_cvt_pk_bf16_f32 v109, v26, v27
v_pk_mul_f32 v[36:37], v[36:37], s[38:39]
v_pk_mul_f32 v[38:39], v[38:39], s[38:39]
v_cvt_pk_bf16_f32 v110, v36, v37
v_cvt_pk_bf16_f32 v111, v38, v39
s_nop 0
v_permlane32_swap_b32 v108, v110
v_permlane32_swap_b32 v109, v111
s_nop 0
v_permlane16_swap_b32 v108, v110
v_permlane16_swap_b32 v109, v111
v_pk_mul_f32 v[28:29], v[28:29], s[38:39]
v_pk_mul_f32 v[30:31], v[30:31], s[38:39]
v_cvt_pk_bf16_f32 v112, v28, v29
v_cvt_pk_bf16_f32 v113, v30, v31
v_pk_mul_f32 v[40:41], v[40:41], s[38:39]
v_pk_mul_f32 v[42:43], v[42:43], s[38:39]
v_cvt_pk_bf16_f32 v114, v40, v41
v_cvt_pk_bf16_f32 v115, v42, v43
s_nop 0
v_permlane32_swap_b32 v112, v114
v_permlane32_swap_b32 v113, v115
s_nop 0
v_permlane16_swap_b32 v112, v114
v_permlane16_swap_b32 v113, v115
v_pk_mul_f32 v[32:33], v[32:33], s[38:39]
v_pk_mul_f32 v[34:35], v[34:35], s[38:39]
v_cvt_pk_bf16_f32 v116, v32, v33
v_cvt_pk_bf16_f32 v117, v34, v35
v_pk_mul_f32 v[44:45], v[44:45], s[38:39]
v_pk_mul_f32 v[46:47], v[46:47], s[38:39]
v_cvt_pk_bf16_f32 v118, v44, v45
v_cvt_pk_bf16_f32 v119, v46, v47
s_nop 0
v_permlane32_swap_b32 v116, v118
v_permlane32_swap_b32 v117, v119
s_nop 0
v_permlane16_swap_b32 v116, v118
v_permlane16_swap_b32 v117, v119
v_pk_mul_f32 v[48:49], v[48:49], s[38:39]
v_pk_mul_f32 v[50:51], v[50:51], s[38:39]
v_cvt_pk_bf16_f32 v120, v48, v49
v_cvt_pk_bf16_f32 v121, v50, v51
v_pk_mul_f32 v[60:61], v[60:61], s[38:39]
v_pk_mul_f32 v[62:63], v[62:63], s[38:39]
v_cvt_pk_bf16_f32 v122, v60, v61
v_cvt_pk_bf16_f32 v123, v62, v63
s_nop 0
v_permlane32_swap_b32 v120, v122
v_permlane32_swap_b32 v121, v123
s_nop 0
v_permlane16_swap_b32 v120, v122
v_permlane16_swap_b32 v121, v123
v_pk_mul_f32 v[52:53], v[52:53], s[38:39]
v_pk_mul_f32 v[54:55], v[54:55], s[38:39]
v_cvt_pk_bf16_f32 v124, v52, v53
v_cvt_pk_bf16_f32 v125, v54, v55
v_pk_mul_f32 v[64:65], v[64:65], s[38:39]
v_pk_mul_f32 v[66:67], v[66:67], s[38:39]
v_cvt_pk_bf16_f32 v126, v64, v65
v_cvt_pk_bf16_f32 v127, v66, v67
s_nop 0
v_permlane32_swap_b32 v124, v126
v_permlane32_swap_b32 v125, v127
s_nop 0
v_permlane16_swap_b32 v124, v126
v_permlane16_swap_b32 v125, v127
v_pk_mul_f32 v[56:57], v[56:57], s[38:39]
v_pk_mul_f32 v[58:59], v[58:59], s[38:39]
v_cvt_pk_bf16_f32 v128, v56, v57
v_cvt_pk_bf16_f32 v129, v58, v59
v_pk_mul_f32 v[68:69], v[68:69], s[38:39]
v_pk_mul_f32 v[70:71], v[70:71], s[38:39]
v_cvt_pk_bf16_f32 v130, v68, v69
v_cvt_pk_bf16_f32 v131, v70, v71
s_nop 0
v_permlane32_swap_b32 v128, v130
v_permlane32_swap_b32 v129, v131
s_nop 0
v_permlane16_swap_b32 v128, v130
v_permlane16_swap_b32 v129, v131
v_pk_mul_f32 v[72:73], v[72:73], s[38:39]
v_pk_mul_f32 v[74:75], v[74:75], s[38:39]
v_cvt_pk_bf16_f32 v132, v72, v73
v_cvt_pk_bf16_f32 v133, v74, v75
v_pk_mul_f32 v[84:85], v[84:85], s[38:39]
v_pk_mul_f32 v[86:87], v[86:87], s[38:39]
v_cvt_pk_bf16_f32 v134, v84, v85
v_cvt_pk_bf16_f32 v135, v86, v87
s_nop 0
v_permlane32_swap_b32 v132, v134
v_permlane32_swap_b32 v133, v135
s_nop 0
v_permlane16_swap_b32 v132, v134
v_permlane16_swap_b32 v133, v135
v_pk_mul_f32 v[76:77], v[76:77], s[38:39]
v_pk_mul_f32 v[78:79], v[78:79], s[38:39]
v_cvt_pk_bf16_f32 v136, v76, v77
v_cvt_pk_bf16_f32 v137, v78, v79
v_pk_mul_f32 v[88:89], v[88:89], s[38:39]
v_pk_mul_f32 v[90:91], v[90:91], s[38:39]
v_cvt_pk_bf16_f32 v138, v88, v89
v_cvt_pk_bf16_f32 v139, v90, v91
s_nop 0
v_permlane32_swap_b32 v136, v138
v_permlane32_swap_b32 v137, v139
s_nop 0
v_permlane16_swap_b32 v136, v138
v_permlane16_swap_b32 v137, v139
v_pk_mul_f32 v[80:81], v[80:81], s[38:39]
v_pk_mul_f32 v[82:83], v[82:83], s[38:39]
v_cvt_pk_bf16_f32 v140, v80, v81
v_cvt_pk_bf16_f32 v141, v82, v83
v_pk_mul_f32 v[92:93], v[92:93], s[38:39]
v_pk_mul_f32 v[94:95], v[94:95], s[38:39]
v_cvt_pk_bf16_f32 v142, v92, v93
v_cvt_pk_bf16_f32 v143, v94, v95
s_nop 0
v_permlane32_swap_b32 v140, v142
v_permlane32_swap_b32 v141, v143
s_nop 0
v_permlane16_swap_b32 v140, v142
v_permlane16_swap_b32 v141, v143
s_mov_b32 m0, s35
s_nop 0
buffer_load_dwordx4 v236, s[12:15], s33 offen nt lds
s_add_u32 s38, s33, 4096
s_add_u32 m0, s35, 4608
s_nop 0
buffer_load_dwordx4 v236, s[12:15], s38 offen nt lds
s_add_u32 s33, s33, 8192
s_add_u32 s49, s49, 1
s_and_b32 s49, s49, 3
s_cmp_eq_u32 s49, 0
s_cselect_b32 s38, s66, s67
s_add_u32 s35, s35, s38
s_mov_b32 m0, s34
s_nop 0
buffer_load_dwordx4 v235, s[8:11], s32 offen nt lds
s_add_u32 s38, s32, 4096
s_add_u32 m0, s34, 4352
s_nop 0
buffer_load_dwordx4 v235, s[8:11], s38 offen nt lds
s_add_u32 s32, s32, 8192
s_add_u32 s48, s48, 1
s_and_b32 s48, s48, 3
s_cmp_eq_u32 s48, 0
s_cselect_b32 s38, s66, s67
s_add_u32 s34, s34, s38
ds_read_b128 v[180:183], v230 offset:0
ds_read_b128 v[184:187], v230 offset:4352
ds_read_b128 v[188:191], v230 offset:64
ds_read_b128 v[192:195], v230 offset:4416
ds_read_b128 v[196:199], v230 offset:128
ds_read_b128 v[200:203], v230 offset:4480
ds_read_b128 v[204:207], v230 offset:192
ds_read_b128 v[208:211], v230 offset:4544
s_waitcnt lgkmcnt(7)
v_mfma_f32_16x16x32_bf16 v[144:147], v[180:183], v[96:99], 0
v_mfma_f32_16x16x32_bf16 v[148:151], v[180:183], v[100:103], 0
v_mfma_f32_16x16x32_bf16 v[152:155], v[180:183], v[104:107], 0
s_waitcnt lgkmcnt(6)
v_mfma_f32_16x16x32_bf16 v[156:159], v[184:187], v[96:99], 0
v_mfma_f32_16x16x32_bf16 v[160:163], v[184:187], v[100:103], 0
v_mfma_f32_16x16x32_bf16 v[164:167], v[184:187], v[104:107], 0
s_waitcnt lgkmcnt(5)
v_mfma_f32_16x16x32_bf16 v[144:147], v[188:191], v[108:111], v[144:147]
v_mfma_f32_16x16x32_bf16 v[148:151], v[188:191], v[112:115], v[148:151]
v_mfma_f32_16x16x32_bf16 v[152:155], v[188:191], v[116:119], v[152:155]
s_waitcnt lgkmcnt(4)
v_mfma_f32_16x16x32_bf16 v[156:159], v[192:195], v[108:111], v[156:159]
v_mfma_f32_16x16x32_bf16 v[160:163], v[192:195], v[112:115], v[160:163]
v_mfma_f32_16x16x32_bf16 v[164:167], v[192:195], v[116:119], v[164:167]
s_waitcnt lgkmcnt(3)
v_mfma_f32_16x16x32_bf16 v[144:147], v[196:199], v[120:123], v[144:147]
v_mfma_f32_16x16x32_bf16 v[148:151], v[196:199], v[124:127], v[148:151]
v_mfma_f32_16x16x32_bf16 v[152:155], v[196:199], v[128:131], v[152:155]
s_waitcnt lgkmcnt(2)
v_mfma_f32_16x16x32_bf16 v[156:159], v[200:203], v[120:123], v[156:159]
v_mfma_f32_16x16x32_bf16 v[160:163], v[200:203], v[124:127], v[160:163]
v_mfma_f32_16x16x32_bf16 v[164:167], v[200:203], v[128:131], v[164:167]
s_waitcnt lgkmcnt(1)
v_mfma_f32_16x16x32_bf16 v[144:147], v[204:207], v[132:135], v[144:147]
v_mfma_f32_16x16x32_bf16 v[148:151], v[204:207], v[136:139], v[148:151]
v_mfma_f32_16x16x32_bf16 v[152:155], v[204:207], v[140:143], v[152:155]
s_waitcnt lgkmcnt(0)
v_mfma_f32_16x16x32_bf16 v[156:159], v[208:211], v[132:135], v[156:159]
v_mfma_f32_16x16x32_bf16 v[160:163], v[208:211], v[136:139], v[160:163]
v_mfma_f32_16x16x32_bf16 v[164:167], v[208:211], v[140:143], v[164:167]
s_nop 1
v_max3_f32 v227, v144, v145, v146
s_nop 2
v_max3_f32 v227, v227, v147, v156
v_max3_f32 v227, v227, v157, v158
v_max_f32 v227, v227, v159
v_max3_f32 v228, v148, v149, v150
v_max3_f32 v228, v228, v151, v160
v_max3_f32 v228, v228, v161, v162
v_max_f32 v228, v228, v163
v_max3_f32 v229, v152, v153, v154
v_max3_f32 v229, v229, v155, v164
v_max3_f32 v229, v229, v165, v166
v_max_f32 v229, v229, v167
v_mov_b32 v244, v227
v_mov_b32 v245, v228
v_mov_b32 v246, v229
v_permlane32_swap_b32 v227, v244
v_permlane32_swap_b32 v228, v245
v_permlane32_swap_b32 v229, v246
v_max_f32 v227, v227, v244
v_max_f32 v228, v228, v245
v_max_f32 v229, v229, v246
v_mov_b32 v244, v227
v_mov_b32 v245, v228
v_mov_b32 v246, v229
v_permlane16_swap_b32 v227, v244
v_permlane16_swap_b32 v228, v245
v_permlane16_swap_b32 v229, v246
v_max_f32 v227, v227, v244
v_max_f32 v228, v228, v245
v_max_f32 v229, v229, v246
v_sub_f32 v144, v144, v227
v_sub_f32 v145, v145, v227
v_sub_f32 v146, v146, v227
v_sub_f32 v147, v147, v227
v_sub_f32 v156, v156, v227
v_sub_f32 v157, v157, v227
v_sub_f32 v158, v158, v227
v_sub_f32 v159, v159, v227
v_sub_f32 v148, v148, v228
v_sub_f32 v149, v149, v228
v_sub_f32 v150, v150, v228
v_sub_f32 v151, v151, v228
v_sub_f32 v160, v160, v228
v_sub_f32 v161, v161, v228
v_sub_f32 v162, v162, v228
v_sub_f32 v163, v163, v228
v_sub_f32 v152, v152, v229
v_sub_f32 v153, v153, v229
v_sub_f32 v154, v154, v229
v_sub_f32 v155, v155, v229
v_sub_f32 v164, v164, v229
v_sub_f32 v165, v165, v229
v_sub_f32 v166, v166, v229
v_sub_f32 v167, v167, v229
v_sub_f32 v212, 0, v227
v_sub_f32 v213, 0, v227
v_sub_f32 v214, 0, v227
v_sub_f32 v215, 0, v227
v_mov_b32 v224, 0
v_sub_f32 v216, 0, v228
v_sub_f32 v217, 0, v228
v_sub_f32 v218, 0, v228
v_sub_f32 v219, 0, v228
v_mov_b32 v225, 0
v_sub_f32 v220, 0, v229
v_sub_f32 v221, 0, v229
v_sub_f32 v222, 0, v229
v_sub_f32 v223, 0, v229
v_mov_b32 v226, 0
v_exp_f32 v144, v144
v_exp_f32 v145, v145
v_exp_f32 v146, v146
v_exp_f32 v147, v147
v_exp_f32 v156, v156
v_exp_f32 v157, v157
v_exp_f32 v158, v158
v_exp_f32 v159, v159
v_exp_f32 v148, v148
v_exp_f32 v149, v149
v_exp_f32 v150, v150
v_exp_f32 v151, v151
v_exp_f32 v160, v160
v_exp_f32 v161, v161
v_exp_f32 v162, v162
v_exp_f32 v163, v163
v_exp_f32 v152, v152
v_exp_f32 v153, v153
v_exp_f32 v154, v154
v_exp_f32 v155, v155
v_exp_f32 v164, v164
v_exp_f32 v165, v165
v_exp_f32 v166, v166
v_exp_f32 v167, v167
v_add_f32 v227, v144, v145
v_add_f32 v244, v146, v147
v_add_f32 v228, v148, v149
v_add_f32 v245, v150, v151
v_add_f32 v229, v152, v153
v_add_f32 v246, v154, v155
v_add_f32 v227, v227, v156
v_add_f32 v244, v244, v157
v_add_f32 v228, v228, v160
v_add_f32 v245, v245, v161
v_add_f32 v229, v229, v164
v_add_f32 v246, v246, v165
v_add_f32 v227, v227, v158
v_add_f32 v244, v244, v159
v_add_f32 v228, v228, v162
v_add_f32 v245, v245, v163
v_add_f32 v229, v229, v166
v_add_f32 v246, v246, v167
v_add_f32 v227, v227, v244
v_add_f32 v228, v228, v245
v_add_f32 v229, v229, v246
ds_read_b64_tr_b16 v[180:181], v231 offset:0
ds_read_b64_tr_b16 v[182:183], v231 offset:4608
ds_read_b64_tr_b16 v[184:185], v232 offset:0
ds_read_b64_tr_b16 v[186:187], v232 offset:4608
ds_read_b64_tr_b16 v[188:189], v233 offset:0
ds_read_b64_tr_b16 v[190:191], v233 offset:4608
ds_read_b64_tr_b16 v[192:193], v234 offset:0
ds_read_b64_tr_b16 v[194:195], v234 offset:4608
v_cvt_pk_bf16_f32 v168, v144, v145
v_cvt_pk_bf16_f32 v169, v146, v147
v_cvt_pk_bf16_f32 v170, v156, v157
v_cvt_pk_bf16_f32 v171, v158, v159
v_cvt_pk_bf16_f32 v172, v148, v149
v_cvt_pk_bf16_f32 v173, v150, v151
v_cvt_pk_bf16_f32 v174, v160, v161
v_cvt_pk_bf16_f32 v175, v162, v163
v_cvt_pk_bf16_f32 v176, v152, v153
v_cvt_pk_bf16_f32 v177, v154, v155
v_cvt_pk_bf16_f32 v178, v164, v165
v_cvt_pk_bf16_f32 v179, v166, v167
v_add_f32 v224, v224, v227
v_add_f32 v225, v225, v228
v_add_f32 v226, v226, v229
v_mov_b32 v0, 0
v_mov_b32 v1, 0
v_mov_b32 v2, 0
v_mov_b32 v3, 0
v_mov_b32 v4, 0
v_mov_b32 v5, 0
v_mov_b32 v6, 0
v_mov_b32 v7, 0
v_mov_b32 v8, 0
v_mov_b32 v9, 0
v_mov_b32 v10, 0
v_mov_b32 v11, 0
v_mov_b32 v12, 0
v_mov_b32 v13, 0
v_mov_b32 v14, 0
v_mov_b32 v15, 0
v_mov_b32 v16, 0
v_mov_b32 v17, 0
v_mov_b32 v18, 0
v_mov_b32 v19, 0
v_mov_b32 v20, 0
v_mov_b32 v21, 0
v_mov_b32 v22, 0
v_mov_b32 v23, 0
v_mov_b32 v24, 0
v_mov_b32 v25, 0
v_mov_b32 v26, 0
v_mov_b32 v27, 0
v_mov_b32 v28, 0
v_mov_b32 v29, 0
v_mov_b32 v30, 0
v_mov_b32 v31, 0
v_mov_b32 v32, 0
v_mov_b32 v33, 0
v_mov_b32 v34, 0
v_mov_b32 v35, 0
v_mov_b32 v36, 0
v_mov_b32 v37, 0
v_mov_b32 v38, 0
v_mov_b32 v39, 0
v_mov_b32 v40, 0
v_mov_b32 v41, 0
v_mov_b32 v42, 0
v_mov_b32 v43, 0
v_mov_b32 v44, 0
v_mov_b32 v45, 0
v_mov_b32 v46, 0
v_mov_b32 v47, 0
v_mov_b32 v48, 0
v_mov_b32 v49, 0
v_mov_b32 v50, 0
v_mov_b32 v51, 0
v_mov_b32 v52, 0
v_mov_b32 v53, 0
v_mov_b32 v54, 0
v_mov_b32 v55, 0
v_mov_b32 v56, 0
v_mov_b32 v57, 0
v_mov_b32 v58, 0
v_mov_b32 v59, 0
v_mov_b32 v60, 0
v_mov_b32 v61, 0
v_mov_b32 v62, 0
v_mov_b32 v63, 0
v_mov_b32 v64, 0
v_mov_b32 v65, 0
v_mov_b32 v66, 0
v_mov_b32 v67, 0
v_mov_b32 v68, 0
v_mov_b32 v69, 0
v_mov_b32 v70, 0
v_mov_b32 v71, 0
v_mov_b32 v72, 0
v_mov_b32 v73, 0
v_mov_b32 v74, 0
v_mov_b32 v75, 0
v_mov_b32 v76, 0
v_mov_b32 v77, 0
v_mov_b32 v78, 0
v_mov_b32 v79, 0
v_mov_b32 v80, 0
v_mov_b32 v81, 0
v_mov_b32 v82, 0
v_mov_b32 v83, 0
v_mov_b32 v84, 0
v_mov_b32 v85, 0
v_mov_b32 v86, 0
v_mov_b32 v87, 0
v_mov_b32 v88, 0
v_mov_b32 v89, 0
v_mov_b32 v90, 0
v_mov_b32 v91, 0
v_mov_b32 v92, 0
v_mov_b32 v93, 0
v_mov_b32 v94, 0
v_mov_b32 v95, 0
s_add_u32 s50, s50, 1
s_and_b32 s50, s50, 3
s_cmp_eq_u32 s50, 0
s_cselect_b32 s39, s66, s67
v_add_u32 v230, s39, v230
s_waitcnt vmcnt(6)
s_waitcnt lgkmcnt(0)
s_barrier
s_mov_b32 s31, 1
LOOP_R1:
s_cmp_gt_u32 s31, 12
s_cbranch_scc1 NOK_R1
s_mov_b32 m0, s35
s_nop 0
buffer_load_dwordx4 v236, s[12:15], s33 offen nt lds
s_add_u32 s38, s33, 4096
s_add_u32 m0, s35, 4608
s_nop 0
buffer_load_dwordx4 v236, s[12:15], s38 offen nt lds
s_add_u32 s33, s33, 8192
s_add_u32 s49, s49, 1
s_and_b32 s49, s49, 3
s_cmp_eq_u32 s49, 0
s_cselect_b32 s38, s66, s67
s_add_u32 s35, s35, s38
s_mov_b32 m0, s34
s_nop 0
buffer_load_dwordx4 v235, s[8:11], s32 offen nt lds
s_add_u32 s38, s32, 4096
s_add_u32 m0, s34, 4352
s_nop 0
buffer_load_dwordx4 v235, s[8:11], s38 offen nt lds
s_add_u32 s32, s32, 8192
s_add_u32 s48, s48, 1
s_and_b32 s48, s48, 3
s_cmp_eq_u32 s48, 0
s_cselect_b32 s38, s66, s67
s_add_u32 s34, s34, s38
s_branch DMADONE_R1
NOK_R1:
s_cmp_gt_u32 s31, 13
s_cbranch_scc1 DMADONE_R1
s_mov_b32 m0, s35
s_nop 0
buffer_load_dwordx4 v236, s[12:15], s33 offen nt lds
s_add_u32 s38, s33, 4096
s_add_u32 m0, s35, 4608
s_nop 0
buffer_load_dwordx4 v236, s[12:15], s38 offen nt lds
s_add_u32 s33, s33, 8192
s_add_u32 s49, s49, 1
s_and_b32 s49, s49, 3
s_cmp_eq_u32 s49, 0
s_cselect_b32 s38, s66, s67
s_add_u32 s35, s35, s38
DMADONE_R1:
v_mfma_f32_16x16x32_bf16 v[0:3], v[180:183], v[168:171], v[0:3]
v_mfma_f32_16x16x32_bf16 v[4:7], v[180:183], v[172:175], v[4:7]
v_mfma_f32_16x16x32_bf16 v[8:11], v[180:183], v[176:179], v[8:11]
ds_read_b64_tr_b16 v[196:197], v231 offset:128
ds_read_b64_tr_b16 v[198:199], v231 offset:4736
ds_read_b128 v[180:183], v230 offset:0
v_mfma_f32_16x16x32_bf16 v[12:15], v[184:187], v[168:171], v[12:15]
v_mfma_f32_16x16x32_bf16 v[16:19], v[184:187], v[172:175], v[16:19]
v_mfma_f32_16x16x32_bf16 v[20:23], v[184:187], v[176:179], v[20:23]
ds_read_b64_tr_b16 v[200:201], v232 offset:128
ds_read_b64_tr_b16 v[202:203], v232 offset:4736
ds_read_b128 v[184:187], v230 offset:4352
v_mfma_f32_16x16x32_bf16 v[24:27], v[188:191], v[168:171], v[24:27]
v_mfma_f32_16x16x32_bf16 v[28:31], v[188:191], v[172:175], v[28:31]
v_mfma_f32_16x16x32_bf16 v[32:35], v[188:191], v[176:179], v[32:35]
ds_read_b64_tr_b16 v[204:205], v233 offset:128
ds_read_b64_tr_b16 v[206:207], v233 offset:4736
ds_read_b128 v[188:191], v230 offset:64
v_mfma_f32_16x16x32_bf16 v[36:39], v[192:195], v[168:171], v[36:39]
v_mfma_f32_16x16x32_bf16 v[40:43], v[192:195], v[172:175], v[40:43]
v_mfma_f32_16x16x32_bf16 v[44:47], v[192:195], v[176:179], v[44:47]
ds_read_b64_tr_b16 v[208:209], v234 offset:128
ds_read_b64_tr_b16 v[210:211], v234 offset:4736
ds_read_b128 v[192:195], v230 offset:4416
s_waitcnt lgkmcnt(10)
v_mfma_f32_16x16x32_bf16 v[48:51], v[196:199], v[168:171], v[48:51]
v_mfma_f32_16x16x32_bf16 v[52:55], v[196:199], v[172:175], v[52:55]
v_mfma_f32_16x16x32_bf16 v[56:59], v[196:199], v[176:179], v[56:59]
ds_read_b128 v[196:199], v230 offset:128
s_waitcnt lgkmcnt(8)
v_mfma_f32_16x16x32_bf16 v[60:63], v[200:203], v[168:171], v[60:63]
v_mfma_f32_16x16x32_bf16 v[64:67], v[200:203], v[172:175], v[64:67]
v_mfma_f32_16x16x32_bf16 v[68:71], v[200:203], v[176:179], v[68:71]
ds_read_b128 v[200:203], v230 offset:4480
s_waitcnt lgkmcnt(6)
v_mfma_f32_16x16x32_bf16 v[72:75], v[204:207], v[168:171], v[72:75]
v_mfma_f32_16x16x32_bf16 v[76:79], v[204:207], v[172:175], v[76:79]
v_mfma_f32_16x16x32_bf16 v[80:83], v[204:207], v[176:179], v[80:83]
ds_read_b128 v[204:207], v230 offset:192
s_waitcnt lgkmcnt(4)
v_mfma_f32_16x16x32_bf16 v[84:87], v[208:211], v[168:171], v[84:87]
v_mfma_f32_16x16x32_bf16 v[88:91], v[208:211], v[172:175], v[88:91]
v_mfma_f32_16x16x32_bf16 v[92:95], v[208:211], v[176:179], v[92:95]
ds_read_b128 v[208:211], v230 offset:4544
s_add_u32 s51, s51, 1
s_and_b32 s51, s51, 3
s_cmp_eq_u32 s51, 0
s_cselect_b32 s39, s66, s67
v_add_u32 v231, s39, v231
v_add_u32 v232, s39, v232
v_add_u32 v233, s39, v233
v_add_u32 v234, s39, v234
s_setprio 1
v_mfma_f32_16x16x32_bf16 v[144:147], v[180:183], v[96:99], v[212:215]
v_mfma_f32_16x16x32_bf16 v[148:151], v[180:183], v[100:103], v[216:219]
v_mfma_f32_16x16x32_bf16 v[152:155], v[180:183], v[104:107], v[220:223]
v_mfma_f32_16x16x32_bf16 v[156:159], v[184:187], v[96:99], v[212:215]
v_mfma_f32_16x16x32_bf16 v[160:163], v[184:187], v[100:103], v[216:219]
v_mfma_f32_16x16x32_bf16 v[164:167], v[184:187], v[104:107], v[220:223]
v_mfma_f32_16x16x32_bf16 v[144:147], v[188:191], v[108:111], v[144:147]
v_mfma_f32_16x16x32_bf16 v[148:151], v[188:191], v[112:115], v[148:151]
v_mfma_f32_16x16x32_bf16 v[152:155], v[188:191], v[116:119], v[152:155]
s_waitcnt lgkmcnt(4)
v_mfma_f32_16x16x32_bf16 v[156:159], v[192:195], v[108:111], v[156:159]
v_mfma_f32_16x16x32_bf16 v[160:163], v[192:195], v[112:115], v[160:163]
v_mfma_f32_16x16x32_bf16 v[164:167], v[192:195], v[116:119], v[164:167]
s_waitcnt lgkmcnt(3)
v_mfma_f32_16x16x32_bf16 v[144:147], v[196:199], v[120:123], v[144:147]
v_mfma_f32_16x16x32_bf16 v[148:151], v[196:199], v[124:127], v[148:151]
v_mfma_f32_16x16x32_bf16 v[152:155], v[196:199], v[128:131], v[152:155]
s_waitcnt lgkmcnt(2)
v_mfma_f32_16x16x32_bf16 v[156:159], v[200:203], v[120:123], v[156:159]
v_mfma_f32_16x16x32_bf16 v[160:163], v[200:203], v[124:127], v[160:163]
v_mfma_f32_16x16x32_bf16 v[164:167], v[200:203], v[128:131], v[164:167]
s_waitcnt lgkmcnt(1)
v_mfma_f32_16x16x32_bf16 v[144:147], v[204:207], v[132:135], v[144:147]
v_mfma_f32_16x16x32_bf16 v[148:151], v[204:207], v[136:139], v[148:151]
v_mfma_f32_16x16x32_bf16 v[152:155], v[204:207], v[140:143], v[152:155]
s_waitcnt lgkmcnt(0)
v_mfma_f32_16x16x32_bf16 v[156:159], v[208:211], v[132:135], v[156:159]
v_mfma_f32_16x16x32_bf16 v[160:163], v[208:211], v[136:139], v[160:163]
v_mfma_f32_16x16x32_bf16 v[164:167], v[208:211], v[140:143], v[164:167]
s_setprio 0
SM_R1:
s_nop 0
v_exp_f32 v144, v144
v_exp_f32 v145, v145
v_exp_f32 v146, v146
v_exp_f32 v147, v147
v_exp_f32 v156, v156
v_exp_f32 v157, v157
v_exp_f32 v158, v158
v_exp_f32 v159, v159
v_exp_f32 v148, v148
v_exp_f32 v149, v149
v_exp_f32 v150, v150
v_exp_f32 v151, v151
v_exp_f32 v160, v160
v_exp_f32 v161, v161
v_exp_f32 v162, v162
v_exp_f32 v163, v163
v_exp_f32 v152, v152
v_exp_f32 v153, v153
v_exp_f32 v154, v154
v_exp_f32 v155, v155
v_exp_f32 v164, v164
v_exp_f32 v165, v165
v_exp_f32 v166, v166
v_exp_f32 v167, v167
v_add_f32 v227, v144, v145
v_add_f32 v244, v146, v147
v_add_f32 v228, v148, v149
v_add_f32 v245, v150, v151
v_add_f32 v229, v152, v153
v_add_f32 v246, v154, v155
v_add_f32 v227, v227, v156
v_add_f32 v244, v244, v157
v_add_f32 v228, v228, v160
v_add_f32 v245, v245, v161
v_add_f32 v229, v229, v164
v_add_f32 v246, v246, v165
v_add_f32 v227, v227, v158
v_add_f32 v244, v244, v159
v_add_f32 v228, v228, v162
v_add_f32 v245, v245, v163
v_add_f32 v229, v229, v166
v_add_f32 v246, v246, v167
v_add_f32 v227, v227, v244
v_add_f32 v228, v228, v245
v_add_f32 v229, v229, v246
v_max3_f32 v244, v227, v228, v229
v_cmp_lt_f32 vcc, s37, v244
s_nop 1
s_cbranch_vccnz RARE_R1
ds_read_b64_tr_b16 v[180:181], v231 offset:0
ds_read_b64_tr_b16 v[182:183], v231 offset:4608
ds_read_b64_tr_b16 v[184:185], v232 offset:0
ds_read_b64_tr_b16 v[186:187], v232 offset:4608
ds_read_b64_tr_b16 v[188:189], v233 offset:0
ds_read_b64_tr_b16 v[190:191], v233 offset:4608
ds_read_b64_tr_b16 v[192:193], v234 offset:0
ds_read_b64_tr_b16 v[194:195], v234 offset:4608
v_cvt_pk_bf16_f32 v168, v144, v145
v_cvt_pk_bf16_f32 v169, v146, v147
v_cvt_pk_bf16_f32 v170, v156, v157
v_cvt_pk_bf16_f32 v171, v158, v159
v_cvt_pk_bf16_f32 v172, v148, v149
v_cvt_pk_bf16_f32 v173, v150, v151
v_cvt_pk_bf16_f32 v174, v160, v161
v_cvt_pk_bf16_f32 v175, v162, v163
v_cvt_pk_bf16_f32 v176, v152, v153
v_cvt_pk_bf16_f32 v177, v154, v155
v_cvt_pk_bf16_f32 v178, v164, v165
v_cvt_pk_bf16_f32 v179, v166, v167
v_add_f32 v224, v224, v227
v_add_f32 v225, v225, v228
v_add_f32 v226, v226, v229
s_add_u32 s50, s50, 1
s_and_b32 s50, s50, 3
s_cmp_eq_u32 s50, 0
s_cselect_b32 s39, s66, s67
v_add_u32 v230, s39, v230
s_waitcnt lgkmcnt(0)
s_cmp_gt_u32 s31, 12
s_cbranch_scc1 TAILW_R1
s_waitcnt vmcnt(6)
s_branch WD_R1
TAILW_R1:
s_waitcnt vmcnt(4)
s_cmp_eq_u32 s31, 13
s_cbranch_scc1 WD_R1
s_waitcnt vmcnt(0)
WD_R1:
s_barrier
s_add_u32 s31, s31, 1
s_cmp_lt_u32 s31, 16
s_cbranch_scc1 LOOP_R1
v_mfma_f32_16x16x32_bf16 v[0:3], v[180:183], v[168:171], v[0:3]
v_mfma_f32_16x16x32_bf16 v[4:7], v[180:183], v[172:175], v[4:7]
v_mfma_f32_16x16x32_bf16 v[8:11], v[180:183], v[176:179], v[8:11]
ds_read_b64_tr_b16 v[196:197], v231 offset:128
ds_read_b64_tr_b16 v[198:199], v231 offset:4736
v_mfma_f32_16x16x32_bf16 v[12:15], v[184:187], v[168:171], v[12:15]
v_mfma_f32_16x16x32_bf16 v[16:19], v[184:187], v[172:175], v[16:19]
v_mfma_f32_16x16x32_bf16 v[20:23], v[184:187], v[176:179], v[20:23]
ds_read_b64_tr_b16 v[200:201], v232 offset:128
ds_read_b64_tr_b16 v[202:203], v232 offset:4736
v_mfma_f32_16x16x32_bf16 v[24:27], v[188:191], v[168:171], v[24:27]
v_mfma_f32_16x16x32_bf16 v[28:31], v[188:191], v[172:175], v[28:31]
v_mfma_f32_16x16x32_bf16 v[32:35], v[188:191], v[176:179], v[32:35]
ds_read_b64_tr_b16 v[204:205], v233 offset:128
ds_read_b64_tr_b16 v[206:207], v233 offset:4736
v_mfma_f32_16x16x32_bf16 v[36:39], v[192:195], v[168:171], v[36:39]
v_mfma_f32_16x16x32_bf16 v[40:43], v[192:195], v[172:175], v[40:43]
v_mfma_f32_16x16x32_bf16 v[44:47], v[192:195], v[176:179], v[44:47]
ds_read_b64_tr_b16 v[208:209], v234 offset:128
ds_read_b64_tr_b16 v[210:211], v234 offset:4736
s_waitcnt lgkmcnt(6)
v_mfma_f32_16x16x32_bf16 v[48:51], v[196:199], v[168:171], v[48:51]
v_mfma_f32_16x16x32_bf16 v[52:55], v[196:199], v[172:175], v[52:55]
v_mfma_f32_16x16x32_bf16 v[56:59], v[196:199], v[176:179], v[56:59]
s_waitcnt lgkmcnt(4)
v_mfma_f32_16x16x32_bf16 v[60:63], v[200:203], v[168:171], v[60:63]
v_mfma_f32_16x16x32_bf16 v[64:67], v[200:203], v[172:175], v[64:67]
v_mfma_f32_16x16x32_bf16 v[68:71], v[200:203], v[176:179], v[68:71]
s_waitcnt lgkmcnt(2)
v_mfma_f32_16x16x32_bf16 v[72:75], v[204:207], v[168:171], v[72:75]
v_mfma_f32_16x16x32_bf16 v[76:79], v[204:207], v[172:175], v[76:79]
v_mfma_f32_16x16x32_bf16 v[80:83], v[204:207], v[176:179], v[80:83]
s_waitcnt lgkmcnt(0)
v_mfma_f32_16x16x32_bf16 v[84:87], v[208:211], v[168:171], v[84:87]
v_mfma_f32_16x16x32_bf16 v[88:91], v[208:211], v[172:175], v[88:91]
v_mfma_f32_16x16x32_bf16 v[92:95], v[208:211], v[176:179], v[92:95]
s_nop 7
v_mov_b32 v244, v224
v_mov_b32 v245, v225
v_mov_b32 v246, v226
v_permlane32_swap_b32 v224, v244
v_permlane32_swap_b32 v225, v245
v_permlane32_swap_b32 v226, v246
v_add_f32 v224, v224, v244
v_add_f32 v225, v225, v245
v_add_f32 v226, v226, v246
v_mov_b32 v244, v224
v_mov_b32 v245, v225
v_mov_b32 v246, v226
v_permlane16_swap_b32 v224, v244
v_permlane16_swap_b32 v225, v245
v_permlane16_swap_b32 v226, v246
v_add_f32 v224, v224, v244
v_add_f32 v225, v225, v245
v_add_f32 v226, v226, v246
v_rcp_f32 v224, v224
v_rcp_f32 v225, v225
v_rcp_f32 v226, v226
v_mov_b32 v212, v224
v_mov_b32 v213, v224
v_mov_b32 v216, v225
v_mov_b32 v217, v225
v_mov_b32 v220, v226
v_mov_b32 v221, v226
v_and_b32 v248, 63, v255
v_lshlrev_b32 v248, 4, v248
v_pk_mul_f32 v[0:1], v[0:1], v[212:213]
v_pk_mul_f32 v[2:3], v[2:3], v[212:213]
v_cvt_pk_bf16_f32 v144, v0, v1
v_cvt_pk_bf16_f32 v145, v2, v3
v_pk_mul_f32 v[12:13], v[12:13], v[212:213]
v_pk_mul_f32 v[14:15], v[14:15], v[212:213]
v_cvt_pk_bf16_f32 v146, v12, v13
v_cvt_pk_bf16_f32 v147, v14, v15
s_add_u32 s38, s36, 0
buffer_store_dwordx4 v[144:147], v248, s[24:27], s38 offen sc0 sc1
v_pk_mul_f32 v[24:25], v[24:25], v[212:213]
v_pk_mul_f32 v[26:27], v[26:27], v[212:213]
v_cvt_pk_bf16_f32 v148, v24, v25
v_cvt_pk_bf16_f32 v149, v26, v27
v_pk_mul_f32 v[36:37], v[36:37], v[212:213]
v_pk_mul_f32 v[38:39], v[38:39], v[212:213]
v_cvt_pk_bf16_f32 v150, v36, v37
v_cvt_pk_bf16_f32 v151, v38, v39
s_add_u32 s38, s36, 1024
buffer_store_dwordx4 v[148:151], v248, s[24:27], s38 offen sc0 sc1
v_pk_mul_f32 v[48:49], v[48:49], v[212:213]
v_pk_mul_f32 v[50:51], v[50:51], v[212:213]
v_cvt_pk_bf16_f32 v152, v48, v49
v_cvt_pk_bf16_f32 v153, v50, v51
v_pk_mul_f32 v[60:61], v[60:61], v[212:213]
v_pk_mul_f32 v[62:63], v[62:63], v[212:213]
v_cvt_pk_bf16_f32 v154, v60, v61
v_cvt_pk_bf16_f32 v155, v62, v63
s_add_u32 s38, s36, 2048
buffer_store_dwordx4 v[152:155], v248, s[24:27], s38 offen sc0 sc1
v_pk_mul_f32 v[72:73], v[72:73], v[212:213]
v_pk_mul_f32 v[74:75], v[74:75], v[212:213]
v_cvt_pk_bf16_f32 v156, v72, v73
v_cvt_pk_bf16_f32 v157, v74, v75
v_pk_mul_f32 v[84:85], v[84:85], v[212:213]
v_pk_mul_f32 v[86:87], v[86:87], v[212:213]
v_cvt_pk_bf16_f32 v158, v84, v85
v_cvt_pk_bf16_f32 v159, v86, v87
s_add_u32 s38, s36, 3072
buffer_store_dwordx4 v[156:159], v248, s[24:27], s38 offen sc0 sc1
v_pk_mul_f32 v[4:5], v[4:5], v[216:217]
v_pk_mul_f32 v[6:7], v[6:7], v[216:217]
v_cvt_pk_bf16_f32 v160, v4, v5
v_cvt_pk_bf16_f32 v161, v6, v7
v_pk_mul_f32 v[16:17], v[16:17], v[216:217]
v_pk_mul_f32 v[18:19], v[18:19], v[216:217]
v_cvt_pk_bf16_f32 v162, v16, v17
v_cvt_pk_bf16_f32 v163, v18, v19
s_add_u32 s38, s36, 4096
buffer_store_dwordx4 v[160:163], v248, s[24:27], s38 offen sc0 sc1
v_pk_mul_f32 v[28:29], v[28:29], v[216:217]
v_pk_mul_f32 v[30:31], v[30:31], v[216:217]
v_cvt_pk_bf16_f32 v164, v28, v29
v_cvt_pk_bf16_f32 v165, v30, v31
v_pk_mul_f32 v[40:41], v[40:41], v[216:217]
v_pk_mul_f32 v[42:43], v[42:43], v[216:217]
v_cvt_pk_bf16_f32 v166, v40, v41
v_cvt_pk_bf16_f32 v167, v42, v43
s_add_u32 s38, s36, 5120
buffer_store_dwordx4 v[164:167], v248, s[24:27], s38 offen sc0 sc1
v_pk_mul_f32 v[52:53], v[52:53], v[216:217]
v_pk_mul_f32 v[54:55], v[54:55], v[216:217]
v_cvt_pk_bf16_f32 v144, v52, v53
v_cvt_pk_bf16_f32 v145, v54, v55
v_pk_mul_f32 v[64:65], v[64:65], v[216:217]
v_pk_mul_f32 v[66:67], v[66:67], v[216:217]
v_cvt_pk_bf16_f32 v146, v64, v65
v_cvt_pk_bf16_f32 v147, v66, v67
s_add_u32 s38, s36, 6144
buffer_store_dwordx4 v[144:147], v248, s[24:27], s38 offen sc0 sc1
v_pk_mul_f32 v[76:77], v[76:77], v[216:217]
v_pk_mul_f32 v[78:79], v[78:79], v[216:217]
v_cvt_pk_bf16_f32 v148, v76, v77
v_cvt_pk_bf16_f32 v149, v78, v79
v_pk_mul_f32 v[88:89], v[88:89], v[216:217]
v_pk_mul_f32 v[90:91], v[90:91], v[216:217]
v_cvt_pk_bf16_f32 v150, v88, v89
v_cvt_pk_bf16_f32 v151, v90, v91
s_add_u32 s38, s36, 7168
buffer_store_dwordx4 v[148:151], v248, s[24:27], s38 offen sc0 sc1
v_pk_mul_f32 v[8:9], v[8:9], v[220:221]
v_pk_mul_f32 v[10:11], v[10:11], v[220:221]
v_cvt_pk_bf16_f32 v152, v8, v9
v_cvt_pk_bf16_f32 v153, v10, v11
v_pk_mul_f32 v[20:21], v[20:21], v[220:221]
v_pk_mul_f32 v[22:23], v[22:23], v[220:221]
v_cvt_pk_bf16_f32 v154, v20, v21
v_cvt_pk_bf16_f32 v155, v22, v23
s_add_u32 s38, s36, 8192
buffer_store_dwordx4 v[152:155], v248, s[24:27], s38 offen sc0 sc1
v_pk_mul_f32 v[32:33], v[32:33], v[220:221]
v_pk_mul_f32 v[34:35], v[34:35], v[220:221]
v_cvt_pk_bf16_f32 v156, v32, v33
v_cvt_pk_bf16_f32 v157, v34, v35
v_pk_mul_f32 v[44:45], v[44:45], v[220:221]
v_pk_mul_f32 v[46:47], v[46:47], v[220:221]
v_cvt_pk_bf16_f32 v158, v44, v45
v_cvt_pk_bf16_f32 v159, v46, v47
s_add_u32 s38, s36, 9216
buffer_store_dwordx4 v[156:159], v248, s[24:27], s38 offen sc0 sc1
v_pk_mul_f32 v[56:57], v[56:57], v[220:221]
v_pk_mul_f32 v[58:59], v[58:59], v[220:221]
v_cvt_pk_bf16_f32 v160, v56, v57
v_cvt_pk_bf16_f32 v161, v58, v59
v_pk_mul_f32 v[68:69], v[68:69], v[220:221]
v_pk_mul_f32 v[70:71], v[70:71], v[220:221]
v_cvt_pk_bf16_f32 v162, v68, v69
v_cvt_pk_bf16_f32 v163, v70, v71
s_add_u32 s38, s36, 10240
buffer_store_dwordx4 v[160:163], v248, s[24:27], s38 offen sc0 sc1
v_pk_mul_f32 v[80:81], v[80:81], v[220:221]
v_pk_mul_f32 v[82:83], v[82:83], v[220:221]
v_cvt_pk_bf16_f32 v164, v80, v81
v_cvt_pk_bf16_f32 v165, v82, v83
v_pk_mul_f32 v[92:93], v[92:93], v[220:221]
v_pk_mul_f32 v[94:95], v[94:95], v[220:221]
v_cvt_pk_bf16_f32 v166, v92, v93
v_cvt_pk_bf16_f32 v167, v94, v95
s_add_u32 s38, s36, 11264
buffer_store_dwordx4 v[164:167], v248, s[24:27], s38 offen sc0 sc1
s_branch K1_END
RARE_R1:
s_waitcnt lgkmcnt(0)
ds_read_b128 v[180:183], v230 offset:0
ds_read_b128 v[184:187], v230 offset:4352
ds_read_b128 v[188:191], v230 offset:64
ds_read_b128 v[192:195], v230 offset:4416
ds_read_b128 v[196:199], v230 offset:128
ds_read_b128 v[200:203], v230 offset:4480
ds_read_b128 v[204:207], v230 offset:192
ds_read_b128 v[208:211], v230 offset:4544
s_waitcnt lgkmcnt(7)
v_mfma_f32_16x16x32_bf16 v[144:147], v[180:183], v[96:99], v[212:215]
v_mfma_f32_16x16x32_bf16 v[148:151], v[180:183], v[100:103], v[216:219]
v_mfma_f32_16x16x32_bf16 v[152:155], v[180:183], v[104:107], v[220:223]
s_waitcnt lgkmcnt(6)
v_mfma_f32_16x16x32_bf16 v[156:159], v[184:187], v[96:99], v[212:215]
v_mfma_f32_16x16x32_bf16 v[160:163], v[184:187], v[100:103], v[216:219]
v_mfma_f32_16x16x32_bf16 v[164:167], v[184:187], v[104:107], v[220:223]
s_waitcnt lgkmcnt(5)
v_mfma_f32_16x16x32_bf16 v[144:147], v[188:191], v[108:111], v[144:147]
v_mfma_f32_16x16x32_bf16 v[148:151], v[188:191], v[112:115], v[148:151]
v_mfma_f32_16x16x32_bf16 v[152:155], v[188:191], v[116:119], v[152:155]
s_waitcnt lgkmcnt(4)
v_mfma_f32_16x16x32_bf16 v[156:159], v[192:195], v[108:111], v[156:159]
v_mfma_f32_16x16x32_bf16 v[160:163], v[192:195], v[112:115], v[160:163]
v_mfma_f32_16x16x32_bf16 v[164:167], v[192:195], v[116:119], v[164:167]
s_waitcnt lgkmcnt(3)
v_mfma_f32_16x16x32_bf16 v[144:147], v[196:199], v[120:123], v[144:147]
v_mfma_f32_16x16x32_bf16 v[148:151], v[196:199], v[124:127], v[148:151]
v_mfma_f32_16x16x32_bf16 v[152:155], v[196:199], v[128:131], v[152:155]
s_waitcnt lgkmcnt(2)
v_mfma_f32_16x16x32_bf16 v[156:159], v[200:203], v[120:123], v[156:159]
v_mfma_f32_16x16x32_bf16 v[160:163], v[200:203], v[124:127], v[160:163]
v_mfma_f32_16x16x32_bf16 v[164:167], v[200:203], v[128:131], v[164:167]
s_waitcnt lgkmcnt(1)
v_mfma_f32_16x16x32_bf16 v[144:147], v[204:207], v[132:135], v[144:147]
v_mfma_f32_16x16x32_bf16 v[148:151], v[204:207], v[136:139], v[148:151]
v_mfma_f32_16x16x32_bf16 v[152:155], v[204:207], v[140:143], v[152:155]
s_waitcnt lgkmcnt(0)
v_mfma_f32_16x16x32_bf16 v[156:159], v[208:211], v[132:135], v[156:159]
v_mfma_f32_16x16x32_bf16 v[160:163], v[208:211], v[136:139], v[160:163]
v_mfma_f32_16x16x32_bf16 v[164:167], v[208:211], v[140:143], v[164:167]
s_nop 1
v_max3_f32 v227, v144, v145, v146
s_nop 2
v_max3_f32 v227, v227, v147, v156
v_max3_f32 v227, v227, v157, v158
v_max_f32 v227, v227, v159
v_max3_f32 v228, v148, v149, v150
v_max3_f32 v228, v228, v151, v160
v_max3_f32 v228, v228, v161, v162
v_max_f32 v228, v228, v163
v_max3_f32 v229, v152, v153, v154
v_max3_f32 v229, v229, v155, v164
v_max3_f32 v229, v229, v165, v166
v_max_f32 v229, v229, v167
v_mov_b32 v244, v227
v_mov_b32 v245, v228
v_mov_b32 v246, v229
v_permlane32_swap_b32 v227, v244
v_permlane32_swap_b32 v228, v245
v_permlane32_swap_b32 v229, v246
v_max_f32 v227, v227, v244
v_max_f32 v228, v228, v245
v_max_f32 v229, v229, v246
v_mov_b32 v244, v227
v_mov_b32 v245, v228
v_mov_b32 v246, v229
v_permlane16_swap_b32 v227, v244
v_permlane16_swap_b32 v228, v245
v_permlane16_swap_b32 v229, v246
v_max_f32 v227, v227, v244
v_max_f32 v228, v228, v245
v_max_f32 v229, v229, v246
v_max_f32 v227, 0, v227
v_max_f32 v228, 0, v228
v_max_f32 v229, 0, v229
v_sub_f32 v144, v144, v227
v_sub_f32 v145, v145, v227
v_sub_f32 v146, v146, v227
v_sub_f32 v147, v147, v227
v_sub_f32 v156, v156, v227
v_sub_f32 v157, v157, v227
v_sub_f32 v158, v158, v227
v_sub_f32 v159, v159, v227
v_sub_f32 v148, v148, v228
v_sub_f32 v149, v149, v228
v_sub_f32 v150, v150, v228
v_sub_f32 v151, v151, v228
v_sub_f32 v160, v160, v228
v_sub_f32 v161, v161, v228
v_sub_f32 v162, v162, v228
v_sub_f32 v163, v163, v228
v_sub_f32 v152, v152, v229
v_sub_f32 v153, v153, v229
v_sub_f32 v154, v154, v229
v_sub_f32 v155, v155, v229
v_sub_f32 v164, v164, v229
v_sub_f32 v165, v165, v229
v_sub_f32 v166, v166, v229
v_sub_f32 v167, v167, v229
v_sub_f32 v212, v212, v227
v_sub_f32 v213, v213, v227
v_sub_f32 v214, v214, v227
v_sub_f32 v215, v215, v227
v_sub_f32 v244, 0, v227
v_exp_f32 v244, v244
v_sub_f32 v216, v216, v228
v_sub_f32 v217, v217, v228
v_sub_f32 v218, v218, v228
v_sub_f32 v219, v219, v228
v_sub_f32 v245, 0, v228
v_exp_f32 v245, v245
v_sub_f32 v220, v220, v229
v_sub_f32 v221, v221, v229
v_sub_f32 v222, v222, v229
v_sub_f32 v223, v223, v229
v_sub_f32 v246, 0, v229
v_exp_f32 v246, v246
v_mul_f32 v224, v224, v244
v_mul_f32 v0, v0, v244
v_mul_f32 v1, v1, v244
v_mul_f32 v2, v2, v244
v_mul_f32 v3, v3, v244
v_mul_f32 v12, v12, v244
v_mul_f32 v13, v13, v244
v_mul_f32 v14, v14, v244
v_mul_f32 v15, v15, v244
v_mul_f32 v24, v24, v244
v_mul_f32 v25, v25, v244
v_mul_f32 v26, v26, v244
v_mul_f32 v27, v27, v244
v_mul_f32 v36, v36, v244
v_mul_f32 v37, v37, v244
v_mul_f32 v38, v38, v244
v_mul_f32 v39, v39, v244
v_mul_f32 v48, v48, v244
v_mul_f32 v49, v49, v244
v_mul_f32 v50, v50, v244
v_mul_f32 v51, v51, v244
v_mul_f32 v60, v60, v244
v_mul_f32 v61, v61, v244
v_mul_f32 v62, v62, v244
v_mul_f32 v63, v63, v244
v_mul_f32 v72, v72, v244
v_mul_f32 v73, v73, v244
v_mul_f32 v74, v74, v244
v_mul_f32 v75, v75, v244
v_mul_f32 v84, v84, v244
v_mul_f32 v85, v85, v244
v_mul_f32 v86, v86, v244
v_mul_f32 v87, v87, v244
v_mul_f32 v225, v225, v245
v_mul_f32 v4, v4, v245
v_mul_f32 v5, v5, v245
v_mul_f32 v6, v6, v245
v_mul_f32 v7, v7, v245
v_mul_f32 v16, v16, v245
v_mul_f32 v17, v17, v245
v_mul_f32 v18, v18, v245
v_mul_f32 v19, v19, v245
v_mul_f32 v28, v28, v245
v_mul_f32 v29, v29, v245
v_mul_f32 v30, v30, v245
v_mul_f32 v31, v31, v245
v_mul_f32 v40, v40, v245
v_mul_f32 v41, v41, v245
v_mul_f32 v42, v42, v245
v_mul_f32 v43, v43, v245
v_mul_f32 v52, v52, v245
v_mul_f32 v53, v53, v245
v_mul_f32 v54, v54, v245
v_mul_f32 v55, v55, v245
v_mul_f32 v64, v64, v245
v_mul_f32 v65, v65, v245
v_mul_f32 v66, v66, v245
v_mul_f32 v67, v67, v245
v_mul_f32 v76, v76, v245
v_mul_f32 v77, v77, v245
v_mul_f32 v78, v78, v245
v_mul_f32 v79, v79, v245
v_mul_f32 v88, v88, v245
v_mul_f32 v89, v89, v245
v_mul_f32 v90, v90, v245
v_mul_f32 v91, v91, v245
v_mul_f32 v226, v226, v246
v_mul_f32 v8, v8, v246
v_mul_f32 v9, v9, v246
v_mul_f32 v10, v10, v246
v_mul_f32 v11, v11, v246
v_mul_f32 v20, v20, v246
v_mul_f32 v21, v21, v246
v_mul_f32 v22, v22, v246
v_mul_f32 v23, v23, v246
v_mul_f32 v32, v32, v246
v_mul_f32 v33, v33, v246
v_mul_f32 v34, v34, v246
v_mul_f32 v35, v35, v246
v_mul_f32 v44, v44, v246
v_mul_f32 v45, v45, v246
v_mul_f32 v46, v46, v246
v_mul_f32 v47, v47, v246
v_mul_f32 v56, v56, v246
v_mul_f32 v57, v57, v246
v_mul_f32 v58, v58, v246
v_mul_f32 v59, v59, v246
v_mul_f32 v68, v68, v246
v_mul_f32 v69, v69, v246
v_mul_f32 v70, v70, v246
v_mul_f32 v71, v71, v246
v_mul_f32 v80, v80, v246
v_mul_f32 v81, v81, v246
v_mul_f32 v82, v82, v246
v_mul_f32 v83, v83, v246
v_mul_f32 v92, v92, v246
v_mul_f32 v93, v93, v246
v_mul_f32 v94, v94, v246
v_mul_f32 v95, v95, v246
s_nop 1
s_branch SM_R1
K1_END:

s_endpgm
.section .rodata,"a"
.p2align 6
.amdhsa_kernel concat_heads__mha_block_cached__mha_block_cached__near_ridge_kernel
  .amdhsa_next_free_vgpr 256
  .amdhsa_next_free_sgpr 96
  .amdhsa_accum_offset 256
  .amdhsa_group_segment_fixed_size 0
  .amdhsa_kernarg_size 104
  .amdhsa_user_sgpr_count 2
  .amdhsa_user_sgpr_kernarg_segment_ptr 1
  .amdhsa_system_sgpr_workgroup_id_x 1
.end_amdhsa_kernel
.text
.globl oproj_kernel
.p2align 8
.type oproj_kernel,@function
oproj_kernel:
s_cmp_ge_u32 s2, 256
s_cbranch_scc1 K2_END
s_load_dwordx2 s[24:25], s[0:1], 96
s_and_b32 s3, s2, 7
s_lshr_b32 s4, s3, 2
s_and_b32 s5, s3, 3
s_lshr_b32 s6, s2, 3
s_and_b32 s7, s6, 7
s_lshr_b32 s6, s6, 3
s_mul_i32 s16, s4, 40
s_add_u32 s16, s0, s16
s_addc_u32 s17, s1, 0
s_load_dwordx2 s[18:19], s[16:17], 32
s_load_dwordx4 s[20:23], s[0:1], 80
v_lshrrev_b32 v1, 6, v0
s_nop 0
v_readfirstlane_b32 s28, v1
v_and_b32 v1, 63, v0
v_lshlrev_b32 v240, 4, v1
v_lshrrev_b32 v2, 4, v1
v_and_b32 v3, 15, v1
v_lshlrev_b32 v4, 1, v2
v_xor_b32 v3, v3, v4
v_lshlrev_b32 v3, 4, v3
v_lshl_add_u32 v241, v2, 10, v3
v_xor_b32 v242, 128, v241
s_and_b32 s34, s28, 3
s_lshr_b32 s35, s28, 2
s_lshl_b32 s33, s28, 11
s_mul_i32 s30, s34, 12288
s_lshl_b32 s36, s35, 10
s_add_u32 s30, s30, s36
s_lshl_b32 s31, s28, 13
s_mul_i32 s60, s7, 2
s_mul_i32 s61, s6, 2
s_add_u32 s60, s60, s61
s_and_b32 s60, s60, 14
s_lshl_b32 s61, s60, 16
s_add_u32 s31, s31, s61
s_lshr_b32 s61, s60, 1
s_mul_i32 s61, s61, 49152
s_add_u32 s30, s30, s61
s_waitcnt lgkmcnt(0)
s_lshl_b32 s37, s4, 3
s_add_u32 s37, s37, s7
s_lshl_b32 s37, s37, 2
s_add_u32 s37, s37, s5
s_mul_i32 s36, s37, 393216
s_add_u32 s8, s24, s36
s_addc_u32 s9, s25, 0
s_mov_b32 s10, 393216
s_mov_b32 s11, 0x20000
s_lshl_b32 s36, s5, 20
s_lshl_b32 s37, s6, 8
s_add_u32 s36, s36, s37
s_add_u32 s12, s18, s36
s_addc_u32 s13, s19, 0
s_sub_u32 s14, 0x100000, s37
s_mov_b32 s15, 0x20000
s_add_u32 m0, s33, 0
s_nop 0
buffer_load_dwordx4 v241, s[12:15], s31 offen lds
s_add_u32 m0, s33, 1024
s_add_u32 s38, s31, 4096
buffer_load_dwordx4 v242, s[12:15], s38 offen lds
buffer_load_dwordx4 v[96:99], v240, s[8:11], s30 offen
s_add_u32 s38, s30, 4096
buffer_load_dwordx4 v[100:103], v240, s[8:11], s38 offen
s_add_u32 s38, s30, 8192
buffer_load_dwordx4 v[104:107], v240, s[8:11], s38 offen
s_add_u32 s30, s30, 2048
s_add_u32 s31, s31, 65536
s_barrier
s_add_u32 m0, s33, 16384
s_nop 0
buffer_load_dwordx4 v241, s[12:15], s31 offen lds
s_add_u32 m0, s33, 17408
s_add_u32 s38, s31, 4096
buffer_load_dwordx4 v242, s[12:15], s38 offen lds
buffer_load_dwordx4 v[108:111], v240, s[8:11], s30 offen
s_add_u32 s38, s30, 4096
buffer_load_dwordx4 v[112:115], v240, s[8:11], s38 offen
s_add_u32 s38, s30, 8192
buffer_load_dwordx4 v[116:119], v240, s[8:11], s38 offen
s_add_u32 s30, s30, 47104
s_add_u32 s31, s31, 65536
s_add_u32 s60, s60, 2
s_cmp_eq_u32 s60, 16
s_cselect_b32 s61, 393216, 0
s_sub_u32 s30, s30, s61
s_cmp_eq_u32 s60, 16
s_cselect_b32 s61, 0x100000, 0
s_sub_u32 s31, s31, s61
s_barrier
s_mul_i32 s36, s5, 3145728
s_mul_i32 s37, s7, 393216
s_add_u32 s36, s36, s37
s_lshl_b32 s37, s4, 10
s_add_u32 s36, s36, s37
s_lshl_b32 s37, s6, 8
s_add_u32 s36, s36, s37
s_add_u32 s36, s36, 33554432
s_add_u32 s40, s24, s36
s_addc_u32 s41, s25, 0
s_mov_b32 s42, 393216
s_mov_b32 s43, 0x20000
v_lshrrev_b32 v2, 2, v1
v_and_b32 v3, 3, v1
v_lshlrev_b32 v3, 3, v3
v_lshl_add_u32 v3, v2, 8, v3
s_lshl_b32 s36, s35, 13
v_add_u32 v3, s36, v3
v_and_b32 v5, 7, v2
v_xor_b32 v6, 0, v5
v_lshl_add_u32 v224, v6, 5, v3
v_add_u32 v232, 65536, v224
v_xor_b32 v6, 1, v5
v_lshl_add_u32 v225, v6, 5, v3
v_add_u32 v233, 65536, v225
v_xor_b32 v6, 2, v5
v_lshl_add_u32 v226, v6, 5, v3
v_add_u32 v234, 65536, v226
v_xor_b32 v6, 3, v5
v_lshl_add_u32 v227, v6, 5, v3
v_add_u32 v235, 65536, v227
v_xor_b32 v6, 4, v5
v_lshl_add_u32 v228, v6, 5, v3
v_add_u32 v236, 65536, v228
v_xor_b32 v6, 5, v5
v_lshl_add_u32 v229, v6, 5, v3
v_add_u32 v237, 65536, v229
v_xor_b32 v6, 6, v5
v_lshl_add_u32 v230, v6, 5, v3
v_add_u32 v238, 65536, v230
v_xor_b32 v6, 7, v5
v_lshl_add_u32 v231, v6, 5, v3
v_add_u32 v239, 65536, v231
v_and_b32 v2, 15, v1
v_lshrrev_b32 v3, 4, v1
s_mul_i32 s36, s34, 48
v_add_u32 v2, s36, v2
v_lshlrev_b32 v2, 11, v2
v_lshl_add_u32 v2, v3, 4, v2
s_lshl_b32 s36, s35, 7
v_add_u32 v243, s36, v2
s_mul_i32 s36, s28, 12288
v_add_u32 v245, s36, v240
s_xor_b32 s37, s28, 4
s_mul_i32 s36, s37, 12288
v_add_u32 v246, s36, v240
s_waitcnt vmcnt(5) lgkmcnt(0)
s_barrier
ds_read_b64_tr_b16 v[192:193], v224 offset:0
ds_read_b64_tr_b16 v[194:195], v224 offset:4096
ds_read_b64_tr_b16 v[196:197], v225 offset:0
ds_read_b64_tr_b16 v[198:199], v225 offset:4096
ds_read_b64_tr_b16 v[200:201], v226 offset:0
ds_read_b64_tr_b16 v[202:203], v226 offset:4096
ds_read_b64_tr_b16 v[204:205], v227 offset:0
ds_read_b64_tr_b16 v[206:207], v227 offset:4096
s_waitcnt lgkmcnt(0)
ds_read_b64_tr_b16 v[208:209], v228 offset:0
ds_read_b64_tr_b16 v[210:211], v228 offset:4096
ds_read_b64_tr_b16 v[212:213], v229 offset:0
ds_read_b64_tr_b16 v[214:215], v229 offset:4096
ds_read_b64_tr_b16 v[216:217], v230 offset:0
ds_read_b64_tr_b16 v[218:219], v230 offset:4096
ds_read_b64_tr_b16 v[220:221], v231 offset:0
ds_read_b64_tr_b16 v[222:223], v231 offset:4096
v_mfma_f32_16x16x32_bf16 v[0:3], v[192:195], v[96:99], 0
v_mfma_f32_16x16x32_bf16 v[4:7], v[192:195], v[100:103], 0
s_add_u32 m0, s33, 32768
s_nop 0
buffer_load_dwordx4 v241, s[12:15], s31 offen lds
v_mfma_f32_16x16x32_bf16 v[8:11], v[192:195], v[104:107], 0
v_mfma_f32_16x16x32_bf16 v[12:15], v[196:199], v[96:99], 0
v_mfma_f32_16x16x32_bf16 v[16:19], v[196:199], v[100:103], 0
v_mfma_f32_16x16x32_bf16 v[20:23], v[196:199], v[104:107], 0
s_add_u32 m0, s33, 33792
s_add_u32 s38, s31, 4096
buffer_load_dwordx4 v242, s[12:15], s38 offen lds
v_mfma_f32_16x16x32_bf16 v[24:27], v[200:203], v[96:99], 0
v_mfma_f32_16x16x32_bf16 v[28:31], v[200:203], v[100:103], 0
v_mfma_f32_16x16x32_bf16 v[32:35], v[200:203], v[104:107], 0
v_mfma_f32_16x16x32_bf16 v[36:39], v[204:207], v[96:99], 0
buffer_load_dwordx4 v[120:123], v240, s[8:11], s30 offen
v_mfma_f32_16x16x32_bf16 v[40:43], v[204:207], v[100:103], 0
v_mfma_f32_16x16x32_bf16 v[44:47], v[204:207], v[104:107], 0
s_add_u32 s38, s30, 4096
buffer_load_dwordx4 v[124:127], v240, s[8:11], s38 offen
s_add_u32 s38, s30, 8192
buffer_load_dwordx4 v[128:131], v240, s[8:11], s38 offen
s_add_u32 s30, s30, 2048
s_add_u32 s31, s31, 65536
s_waitcnt vmcnt(5) lgkmcnt(0)
s_barrier
ds_read_b64_tr_b16 v[192:193], v224 offset:16384
ds_read_b64_tr_b16 v[194:195], v224 offset:20480
ds_read_b64_tr_b16 v[196:197], v225 offset:16384
ds_read_b64_tr_b16 v[198:199], v225 offset:20480
ds_read_b64_tr_b16 v[200:201], v226 offset:16384
ds_read_b64_tr_b16 v[202:203], v226 offset:20480
ds_read_b64_tr_b16 v[204:205], v227 offset:16384
ds_read_b64_tr_b16 v[206:207], v227 offset:20480
v_mfma_f32_16x16x32_bf16 v[48:51], v[208:211], v[96:99], 0
v_mfma_f32_16x16x32_bf16 v[52:55], v[208:211], v[100:103], 0
v_mfma_f32_16x16x32_bf16 v[56:59], v[208:211], v[104:107], 0
v_mfma_f32_16x16x32_bf16 v[60:63], v[212:215], v[96:99], 0
s_add_u32 m0, s33, 49152
s_nop 0
buffer_load_dwordx4 v241, s[12:15], s31 offen lds
v_mfma_f32_16x16x32_bf16 v[64:67], v[212:215], v[100:103], 0
v_mfma_f32_16x16x32_bf16 v[68:71], v[212:215], v[104:107], 0
v_mfma_f32_16x16x32_bf16 v[72:75], v[216:219], v[96:99], 0
v_mfma_f32_16x16x32_bf16 v[76:79], v[216:219], v[100:103], 0
v_mfma_f32_16x16x32_bf16 v[80:83], v[216:219], v[104:107], 0
s_add_u32 m0, s33, 50176
s_add_u32 s38, s31, 4096
buffer_load_dwordx4 v242, s[12:15], s38 offen lds
v_mfma_f32_16x16x32_bf16 v[84:87], v[220:223], v[96:99], 0
v_mfma_f32_16x16x32_bf16 v[88:91], v[220:223], v[100:103], 0
v_mfma_f32_16x16x32_bf16 v[92:95], v[220:223], v[104:107], 0
s_waitcnt lgkmcnt(0)
ds_read_b64_tr_b16 v[208:209], v228 offset:16384
ds_read_b64_tr_b16 v[210:211], v228 offset:20480
ds_read_b64_tr_b16 v[212:213], v229 offset:16384
ds_read_b64_tr_b16 v[214:215], v229 offset:20480
ds_read_b64_tr_b16 v[216:217], v230 offset:16384
ds_read_b64_tr_b16 v[218:219], v230 offset:20480
ds_read_b64_tr_b16 v[220:221], v231 offset:16384
ds_read_b64_tr_b16 v[222:223], v231 offset:20480
v_mfma_f32_16x16x32_bf16 v[0:3], v[192:195], v[108:111], v[0:3]
v_mfma_f32_16x16x32_bf16 v[4:7], v[192:195], v[112:115], v[4:7]
buffer_load_dwordx4 v[132:135], v240, s[8:11], s30 offen
v_mfma_f32_16x16x32_bf16 v[8:11], v[192:195], v[116:119], v[8:11]
v_mfma_f32_16x16x32_bf16 v[12:15], v[196:199], v[108:111], v[12:15]
v_mfma_f32_16x16x32_bf16 v[16:19], v[196:199], v[112:115], v[16:19]
v_mfma_f32_16x16x32_bf16 v[20:23], v[196:199], v[116:119], v[20:23]
s_add_u32 s38, s30, 4096
buffer_load_dwordx4 v[136:139], v240, s[8:11], s38 offen
v_mfma_f32_16x16x32_bf16 v[24:27], v[200:203], v[108:111], v[24:27]
v_mfma_f32_16x16x32_bf16 v[28:31], v[200:203], v[112:115], v[28:31]
v_mfma_f32_16x16x32_bf16 v[32:35], v[200:203], v[116:119], v[32:35]
v_mfma_f32_16x16x32_bf16 v[36:39], v[204:207], v[108:111], v[36:39]
s_add_u32 s38, s30, 8192
buffer_load_dwordx4 v[140:143], v240, s[8:11], s38 offen
s_add_u32 s30, s30, 47104
s_add_u32 s31, s31, 65536
s_add_u32 s60, s60, 2
s_cmp_eq_u32 s60, 16
s_cselect_b32 s61, 393216, 0
s_sub_u32 s30, s30, s61
s_cmp_eq_u32 s60, 16
s_cselect_b32 s61, 0x100000, 0
s_sub_u32 s31, s31, s61
v_mfma_f32_16x16x32_bf16 v[40:43], v[204:207], v[112:115], v[40:43]
v_mfma_f32_16x16x32_bf16 v[44:47], v[204:207], v[116:119], v[44:47]
s_waitcnt vmcnt(5) lgkmcnt(0)
s_barrier
ds_read_b64_tr_b16 v[192:193], v224 offset:32768
ds_read_b64_tr_b16 v[194:195], v224 offset:36864
ds_read_b64_tr_b16 v[196:197], v225 offset:32768
ds_read_b64_tr_b16 v[198:199], v225 offset:36864
ds_read_b64_tr_b16 v[200:201], v226 offset:32768
ds_read_b64_tr_b16 v[202:203], v226 offset:36864
ds_read_b64_tr_b16 v[204:205], v227 offset:32768
ds_read_b64_tr_b16 v[206:207], v227 offset:36864
v_mfma_f32_16x16x32_bf16 v[48:51], v[208:211], v[108:111], v[48:51]
v_mfma_f32_16x16x32_bf16 v[52:55], v[208:211], v[112:115], v[52:55]
v_mfma_f32_16x16x32_bf16 v[56:59], v[208:211], v[116:119], v[56:59]
v_mfma_f32_16x16x32_bf16 v[60:63], v[212:215], v[108:111], v[60:63]
s_add_u32 m0, s33, 65536
s_nop 0
buffer_load_dwordx4 v241, s[12:15], s31 offen lds
v_mfma_f32_16x16x32_bf16 v[64:67], v[212:215], v[112:115], v[64:67]
v_mfma_f32_16x16x32_bf16 v[68:71], v[212:215], v[116:119], v[68:71]
v_mfma_f32_16x16x32_bf16 v[72:75], v[216:219], v[108:111], v[72:75]
v_mfma_f32_16x16x32_bf16 v[76:79], v[216:219], v[112:115], v[76:79]
v_mfma_f32_16x16x32_bf16 v[80:83], v[216:219], v[116:119], v[80:83]
s_add_u32 m0, s33, 66560
s_add_u32 s38, s31, 4096
buffer_load_dwordx4 v242, s[12:15], s38 offen lds
v_mfma_f32_16x16x32_bf16 v[84:87], v[220:223], v[108:111], v[84:87]
v_mfma_f32_16x16x32_bf16 v[88:91], v[220:223], v[112:115], v[88:91]
v_mfma_f32_16x16x32_bf16 v[92:95], v[220:223], v[116:119], v[92:95]
s_waitcnt lgkmcnt(0)
ds_read_b64_tr_b16 v[208:209], v228 offset:32768
ds_read_b64_tr_b16 v[210:211], v228 offset:36864
ds_read_b64_tr_b16 v[212:213], v229 offset:32768
ds_read_b64_tr_b16 v[214:215], v229 offset:36864
ds_read_b64_tr_b16 v[216:217], v230 offset:32768
ds_read_b64_tr_b16 v[218:219], v230 offset:36864
ds_read_b64_tr_b16 v[220:221], v231 offset:32768
ds_read_b64_tr_b16 v[222:223], v231 offset:36864
v_mfma_f32_16x16x32_bf16 v[0:3], v[192:195], v[120:123], v[0:3]
v_mfma_f32_16x16x32_bf16 v[4:7], v[192:195], v[124:127], v[4:7]
buffer_load_dwordx4 v[144:147], v240, s[8:11], s30 offen
v_mfma_f32_16x16x32_bf16 v[8:11], v[192:195], v[128:131], v[8:11]
v_mfma_f32_16x16x32_bf16 v[12:15], v[196:199], v[120:123], v[12:15]
v_mfma_f32_16x16x32_bf16 v[16:19], v[196:199], v[124:127], v[16:19]
v_mfma_f32_16x16x32_bf16 v[20:23], v[196:199], v[128:131], v[20:23]
s_add_u32 s38, s30, 4096
buffer_load_dwordx4 v[148:151], v240, s[8:11], s38 offen
v_mfma_f32_16x16x32_bf16 v[24:27], v[200:203], v[120:123], v[24:27]
v_mfma_f32_16x16x32_bf16 v[28:31], v[200:203], v[124:127], v[28:31]
v_mfma_f32_16x16x32_bf16 v[32:35], v[200:203], v[128:131], v[32:35]
v_mfma_f32_16x16x32_bf16 v[36:39], v[204:207], v[120:123], v[36:39]
s_add_u32 s38, s30, 8192
buffer_load_dwordx4 v[152:155], v240, s[8:11], s38 offen
s_add_u32 s30, s30, 2048
s_add_u32 s31, s31, 65536
v_mfma_f32_16x16x32_bf16 v[40:43], v[204:207], v[124:127], v[40:43]
v_mfma_f32_16x16x32_bf16 v[44:47], v[204:207], v[128:131], v[44:47]
s_waitcnt vmcnt(5) lgkmcnt(0)
s_barrier
ds_read_b64_tr_b16 v[192:193], v224 offset:49152
ds_read_b64_tr_b16 v[194:195], v224 offset:53248
ds_read_b64_tr_b16 v[196:197], v225 offset:49152
ds_read_b64_tr_b16 v[198:199], v225 offset:53248
ds_read_b64_tr_b16 v[200:201], v226 offset:49152
ds_read_b64_tr_b16 v[202:203], v226 offset:53248
ds_read_b64_tr_b16 v[204:205], v227 offset:49152
ds_read_b64_tr_b16 v[206:207], v227 offset:53248
v_mfma_f32_16x16x32_bf16 v[48:51], v[208:211], v[120:123], v[48:51]
v_mfma_f32_16x16x32_bf16 v[52:55], v[208:211], v[124:127], v[52:55]
v_mfma_f32_16x16x32_bf16 v[56:59], v[208:211], v[128:131], v[56:59]
v_mfma_f32_16x16x32_bf16 v[60:63], v[212:215], v[120:123], v[60:63]
s_add_u32 m0, s33, 81920
s_nop 0
buffer_load_dwordx4 v241, s[12:15], s31 offen lds
v_mfma_f32_16x16x32_bf16 v[64:67], v[212:215], v[124:127], v[64:67]
v_mfma_f32_16x16x32_bf16 v[68:71], v[212:215], v[128:131], v[68:71]
v_mfma_f32_16x16x32_bf16 v[72:75], v[216:219], v[120:123], v[72:75]
v_mfma_f32_16x16x32_bf16 v[76:79], v[216:219], v[124:127], v[76:79]
v_mfma_f32_16x16x32_bf16 v[80:83], v[216:219], v[128:131], v[80:83]
s_add_u32 m0, s33, 82944
s_add_u32 s38, s31, 4096
buffer_load_dwordx4 v242, s[12:15], s38 offen lds
v_mfma_f32_16x16x32_bf16 v[84:87], v[220:223], v[120:123], v[84:87]
v_mfma_f32_16x16x32_bf16 v[88:91], v[220:223], v[124:127], v[88:91]
v_mfma_f32_16x16x32_bf16 v[92:95], v[220:223], v[128:131], v[92:95]
s_waitcnt lgkmcnt(0)
ds_read_b64_tr_b16 v[208:209], v228 offset:49152
ds_read_b64_tr_b16 v[210:211], v228 offset:53248
ds_read_b64_tr_b16 v[212:213], v229 offset:49152
ds_read_b64_tr_b16 v[214:215], v229 offset:53248
ds_read_b64_tr_b16 v[216:217], v230 offset:49152
ds_read_b64_tr_b16 v[218:219], v230 offset:53248
ds_read_b64_tr_b16 v[220:221], v231 offset:49152
ds_read_b64_tr_b16 v[222:223], v231 offset:53248
v_mfma_f32_16x16x32_bf16 v[0:3], v[192:195], v[132:135], v[0:3]
v_mfma_f32_16x16x32_bf16 v[4:7], v[192:195], v[136:139], v[4:7]
buffer_load_dwordx4 v[156:159], v240, s[8:11], s30 offen
v_mfma_f32_16x16x32_bf16 v[8:11], v[192:195], v[140:143], v[8:11]
v_mfma_f32_16x16x32_bf16 v[12:15], v[196:199], v[132:135], v[12:15]
v_mfma_f32_16x16x32_bf16 v[16:19], v[196:199], v[136:139], v[16:19]
v_mfma_f32_16x16x32_bf16 v[20:23], v[196:199], v[140:143], v[20:23]
s_add_u32 s38, s30, 4096
buffer_load_dwordx4 v[160:163], v240, s[8:11], s38 offen
v_mfma_f32_16x16x32_bf16 v[24:27], v[200:203], v[132:135], v[24:27]
v_mfma_f32_16x16x32_bf16 v[28:31], v[200:203], v[136:139], v[28:31]
v_mfma_f32_16x16x32_bf16 v[32:35], v[200:203], v[140:143], v[32:35]
v_mfma_f32_16x16x32_bf16 v[36:39], v[204:207], v[132:135], v[36:39]
s_add_u32 s38, s30, 8192
buffer_load_dwordx4 v[164:167], v240, s[8:11], s38 offen
s_add_u32 s30, s30, 47104
s_add_u32 s31, s31, 65536
s_add_u32 s60, s60, 2
s_cmp_eq_u32 s60, 16
s_cselect_b32 s61, 393216, 0
s_sub_u32 s30, s30, s61
s_cmp_eq_u32 s60, 16
s_cselect_b32 s61, 0x100000, 0
s_sub_u32 s31, s31, s61
v_mfma_f32_16x16x32_bf16 v[40:43], v[204:207], v[136:139], v[40:43]
v_mfma_f32_16x16x32_bf16 v[44:47], v[204:207], v[140:143], v[44:47]
s_waitcnt vmcnt(5) lgkmcnt(0)
s_barrier
ds_read_b64_tr_b16 v[192:193], v232 offset:0
ds_read_b64_tr_b16 v[194:195], v232 offset:4096
ds_read_b64_tr_b16 v[196:197], v233 offset:0
ds_read_b64_tr_b16 v[198:199], v233 offset:4096
ds_read_b64_tr_b16 v[200:201], v234 offset:0
ds_read_b64_tr_b16 v[202:203], v234 offset:4096
ds_read_b64_tr_b16 v[204:205], v235 offset:0
ds_read_b64_tr_b16 v[206:207], v235 offset:4096
v_mfma_f32_16x16x32_bf16 v[48:51], v[208:211], v[132:135], v[48:51]
v_mfma_f32_16x16x32_bf16 v[52:55], v[208:211], v[136:139], v[52:55]
v_mfma_f32_16x16x32_bf16 v[56:59], v[208:211], v[140:143], v[56:59]
v_mfma_f32_16x16x32_bf16 v[60:63], v[212:215], v[132:135], v[60:63]
s_add_u32 m0, s33, 98304
s_nop 0
buffer_load_dwordx4 v241, s[12:15], s31 offen lds
v_mfma_f32_16x16x32_bf16 v[64:67], v[212:215], v[136:139], v[64:67]
v_mfma_f32_16x16x32_bf16 v[68:71], v[212:215], v[140:143], v[68:71]
v_mfma_f32_16x16x32_bf16 v[72:75], v[216:219], v[132:135], v[72:75]
v_mfma_f32_16x16x32_bf16 v[76:79], v[216:219], v[136:139], v[76:79]
v_mfma_f32_16x16x32_bf16 v[80:83], v[216:219], v[140:143], v[80:83]
s_add_u32 m0, s33, 99328
s_add_u32 s38, s31, 4096
buffer_load_dwordx4 v242, s[12:15], s38 offen lds
v_mfma_f32_16x16x32_bf16 v[84:87], v[220:223], v[132:135], v[84:87]
v_mfma_f32_16x16x32_bf16 v[88:91], v[220:223], v[136:139], v[88:91]
v_mfma_f32_16x16x32_bf16 v[92:95], v[220:223], v[140:143], v[92:95]
s_waitcnt lgkmcnt(0)
ds_read_b64_tr_b16 v[208:209], v236 offset:0
ds_read_b64_tr_b16 v[210:211], v236 offset:4096
ds_read_b64_tr_b16 v[212:213], v237 offset:0
ds_read_b64_tr_b16 v[214:215], v237 offset:4096
ds_read_b64_tr_b16 v[216:217], v238 offset:0
ds_read_b64_tr_b16 v[218:219], v238 offset:4096
ds_read_b64_tr_b16 v[220:221], v239 offset:0
ds_read_b64_tr_b16 v[222:223], v239 offset:4096
v_mfma_f32_16x16x32_bf16 v[0:3], v[192:195], v[144:147], v[0:3]
v_mfma_f32_16x16x32_bf16 v[4:7], v[192:195], v[148:151], v[4:7]
buffer_load_dwordx4 v[168:171], v240, s[8:11], s30 offen
v_mfma_f32_16x16x32_bf16 v[8:11], v[192:195], v[152:155], v[8:11]
v_mfma_f32_16x16x32_bf16 v[12:15], v[196:199], v[144:147], v[12:15]
v_mfma_f32_16x16x32_bf16 v[16:19], v[196:199], v[148:151], v[16:19]
v_mfma_f32_16x16x32_bf16 v[20:23], v[196:199], v[152:155], v[20:23]
s_add_u32 s38, s30, 4096
buffer_load_dwordx4 v[172:175], v240, s[8:11], s38 offen
v_mfma_f32_16x16x32_bf16 v[24:27], v[200:203], v[144:147], v[24:27]
v_mfma_f32_16x16x32_bf16 v[28:31], v[200:203], v[148:151], v[28:31]
v_mfma_f32_16x16x32_bf16 v[32:35], v[200:203], v[152:155], v[32:35]
v_mfma_f32_16x16x32_bf16 v[36:39], v[204:207], v[144:147], v[36:39]
s_add_u32 s38, s30, 8192
buffer_load_dwordx4 v[176:179], v240, s[8:11], s38 offen
s_add_u32 s30, s30, 2048
s_add_u32 s31, s31, 65536
v_mfma_f32_16x16x32_bf16 v[40:43], v[204:207], v[148:151], v[40:43]
v_mfma_f32_16x16x32_bf16 v[44:47], v[204:207], v[152:155], v[44:47]
s_waitcnt vmcnt(5) lgkmcnt(0)
s_barrier
ds_read_b64_tr_b16 v[192:193], v232 offset:16384
ds_read_b64_tr_b16 v[194:195], v232 offset:20480
ds_read_b64_tr_b16 v[196:197], v233 offset:16384
ds_read_b64_tr_b16 v[198:199], v233 offset:20480
ds_read_b64_tr_b16 v[200:201], v234 offset:16384
ds_read_b64_tr_b16 v[202:203], v234 offset:20480
ds_read_b64_tr_b16 v[204:205], v235 offset:16384
ds_read_b64_tr_b16 v[206:207], v235 offset:20480
v_mfma_f32_16x16x32_bf16 v[48:51], v[208:211], v[144:147], v[48:51]
v_mfma_f32_16x16x32_bf16 v[52:55], v[208:211], v[148:151], v[52:55]
v_mfma_f32_16x16x32_bf16 v[56:59], v[208:211], v[152:155], v[56:59]
v_mfma_f32_16x16x32_bf16 v[60:63], v[212:215], v[144:147], v[60:63]
s_add_u32 m0, s33, 114688
s_nop 0
buffer_load_dwordx4 v241, s[12:15], s31 offen lds
v_mfma_f32_16x16x32_bf16 v[64:67], v[212:215], v[148:151], v[64:67]
v_mfma_f32_16x16x32_bf16 v[68:71], v[212:215], v[152:155], v[68:71]
v_mfma_f32_16x16x32_bf16 v[72:75], v[216:219], v[144:147], v[72:75]
v_mfma_f32_16x16x32_bf16 v[76:79], v[216:219], v[148:151], v[76:79]
v_mfma_f32_16x16x32_bf16 v[80:83], v[216:219], v[152:155], v[80:83]
s_add_u32 m0, s33, 115712
s_add_u32 s38, s31, 4096
buffer_load_dwordx4 v242, s[12:15], s38 offen lds
v_mfma_f32_16x16x32_bf16 v[84:87], v[220:223], v[144:147], v[84:87]
v_mfma_f32_16x16x32_bf16 v[88:91], v[220:223], v[148:151], v[88:91]
v_mfma_f32_16x16x32_bf16 v[92:95], v[220:223], v[152:155], v[92:95]
s_waitcnt lgkmcnt(0)
ds_read_b64_tr_b16 v[208:209], v236 offset:16384
ds_read_b64_tr_b16 v[210:211], v236 offset:20480
ds_read_b64_tr_b16 v[212:213], v237 offset:16384
ds_read_b64_tr_b16 v[214:215], v237 offset:20480
ds_read_b64_tr_b16 v[216:217], v238 offset:16384
ds_read_b64_tr_b16 v[218:219], v238 offset:20480
ds_read_b64_tr_b16 v[220:221], v239 offset:16384
ds_read_b64_tr_b16 v[222:223], v239 offset:20480
v_mfma_f32_16x16x32_bf16 v[0:3], v[192:195], v[156:159], v[0:3]
v_mfma_f32_16x16x32_bf16 v[4:7], v[192:195], v[160:163], v[4:7]
buffer_load_dwordx4 v[180:183], v240, s[8:11], s30 offen
v_mfma_f32_16x16x32_bf16 v[8:11], v[192:195], v[164:167], v[8:11]
v_mfma_f32_16x16x32_bf16 v[12:15], v[196:199], v[156:159], v[12:15]
v_mfma_f32_16x16x32_bf16 v[16:19], v[196:199], v[160:163], v[16:19]
v_mfma_f32_16x16x32_bf16 v[20:23], v[196:199], v[164:167], v[20:23]
s_add_u32 s38, s30, 4096
buffer_load_dwordx4 v[184:187], v240, s[8:11], s38 offen
v_mfma_f32_16x16x32_bf16 v[24:27], v[200:203], v[156:159], v[24:27]
v_mfma_f32_16x16x32_bf16 v[28:31], v[200:203], v[160:163], v[28:31]
v_mfma_f32_16x16x32_bf16 v[32:35], v[200:203], v[164:167], v[32:35]
v_mfma_f32_16x16x32_bf16 v[36:39], v[204:207], v[156:159], v[36:39]
s_add_u32 s38, s30, 8192
buffer_load_dwordx4 v[188:191], v240, s[8:11], s38 offen
s_add_u32 s30, s30, 47104
s_add_u32 s31, s31, 65536
s_add_u32 s60, s60, 2
s_cmp_eq_u32 s60, 16
s_cselect_b32 s61, 393216, 0
s_sub_u32 s30, s30, s61
s_cmp_eq_u32 s60, 16
s_cselect_b32 s61, 0x100000, 0
s_sub_u32 s31, s31, s61
v_mfma_f32_16x16x32_bf16 v[40:43], v[204:207], v[160:163], v[40:43]
v_mfma_f32_16x16x32_bf16 v[44:47], v[204:207], v[164:167], v[44:47]
s_waitcnt vmcnt(5) lgkmcnt(0)
s_barrier
ds_read_b64_tr_b16 v[192:193], v232 offset:32768
ds_read_b64_tr_b16 v[194:195], v232 offset:36864
ds_read_b64_tr_b16 v[196:197], v233 offset:32768
ds_read_b64_tr_b16 v[198:199], v233 offset:36864
ds_read_b64_tr_b16 v[200:201], v234 offset:32768
ds_read_b64_tr_b16 v[202:203], v234 offset:36864
ds_read_b64_tr_b16 v[204:205], v235 offset:32768
ds_read_b64_tr_b16 v[206:207], v235 offset:36864
v_mfma_f32_16x16x32_bf16 v[48:51], v[208:211], v[156:159], v[48:51]
v_mfma_f32_16x16x32_bf16 v[52:55], v[208:211], v[160:163], v[52:55]
v_mfma_f32_16x16x32_bf16 v[56:59], v[208:211], v[164:167], v[56:59]
v_mfma_f32_16x16x32_bf16 v[60:63], v[212:215], v[156:159], v[60:63]
s_add_u32 m0, s33, 0
s_nop 0
buffer_load_dwordx4 v241, s[12:15], s31 offen lds
v_mfma_f32_16x16x32_bf16 v[64:67], v[212:215], v[160:163], v[64:67]
v_mfma_f32_16x16x32_bf16 v[68:71], v[212:215], v[164:167], v[68:71]
v_mfma_f32_16x16x32_bf16 v[72:75], v[216:219], v[156:159], v[72:75]
v_mfma_f32_16x16x32_bf16 v[76:79], v[216:219], v[160:163], v[76:79]
v_mfma_f32_16x16x32_bf16 v[80:83], v[216:219], v[164:167], v[80:83]
s_add_u32 m0, s33, 1024
s_add_u32 s38, s31, 4096
buffer_load_dwordx4 v242, s[12:15], s38 offen lds
v_mfma_f32_16x16x32_bf16 v[84:87], v[220:223], v[156:159], v[84:87]
v_mfma_f32_16x16x32_bf16 v[88:91], v[220:223], v[160:163], v[88:91]
v_mfma_f32_16x16x32_bf16 v[92:95], v[220:223], v[164:167], v[92:95]
s_waitcnt lgkmcnt(0)
ds_read_b64_tr_b16 v[208:209], v236 offset:32768
ds_read_b64_tr_b16 v[210:211], v236 offset:36864
ds_read_b64_tr_b16 v[212:213], v237 offset:32768
ds_read_b64_tr_b16 v[214:215], v237 offset:36864
ds_read_b64_tr_b16 v[216:217], v238 offset:32768
ds_read_b64_tr_b16 v[218:219], v238 offset:36864
ds_read_b64_tr_b16 v[220:221], v239 offset:32768
ds_read_b64_tr_b16 v[222:223], v239 offset:36864
v_mfma_f32_16x16x32_bf16 v[0:3], v[192:195], v[168:171], v[0:3]
v_mfma_f32_16x16x32_bf16 v[4:7], v[192:195], v[172:175], v[4:7]
buffer_load_dwordx4 v[96:99], v240, s[8:11], s30 offen
v_mfma_f32_16x16x32_bf16 v[8:11], v[192:195], v[176:179], v[8:11]
v_mfma_f32_16x16x32_bf16 v[12:15], v[196:199], v[168:171], v[12:15]
v_mfma_f32_16x16x32_bf16 v[16:19], v[196:199], v[172:175], v[16:19]
v_mfma_f32_16x16x32_bf16 v[20:23], v[196:199], v[176:179], v[20:23]
s_add_u32 s38, s30, 4096
buffer_load_dwordx4 v[100:103], v240, s[8:11], s38 offen
v_mfma_f32_16x16x32_bf16 v[24:27], v[200:203], v[168:171], v[24:27]
v_mfma_f32_16x16x32_bf16 v[28:31], v[200:203], v[172:175], v[28:31]
v_mfma_f32_16x16x32_bf16 v[32:35], v[200:203], v[176:179], v[32:35]
v_mfma_f32_16x16x32_bf16 v[36:39], v[204:207], v[168:171], v[36:39]
s_add_u32 s38, s30, 8192
buffer_load_dwordx4 v[104:107], v240, s[8:11], s38 offen
s_add_u32 s30, s30, 2048
s_add_u32 s31, s31, 65536
v_mfma_f32_16x16x32_bf16 v[40:43], v[204:207], v[172:175], v[40:43]
v_mfma_f32_16x16x32_bf16 v[44:47], v[204:207], v[176:179], v[44:47]
s_waitcnt vmcnt(5) lgkmcnt(0)
s_barrier
ds_read_b64_tr_b16 v[192:193], v232 offset:49152
ds_read_b64_tr_b16 v[194:195], v232 offset:53248
ds_read_b64_tr_b16 v[196:197], v233 offset:49152
ds_read_b64_tr_b16 v[198:199], v233 offset:53248
ds_read_b64_tr_b16 v[200:201], v234 offset:49152
ds_read_b64_tr_b16 v[202:203], v234 offset:53248
ds_read_b64_tr_b16 v[204:205], v235 offset:49152
ds_read_b64_tr_b16 v[206:207], v235 offset:53248
v_mfma_f32_16x16x32_bf16 v[48:51], v[208:211], v[168:171], v[48:51]
v_mfma_f32_16x16x32_bf16 v[52:55], v[208:211], v[172:175], v[52:55]
v_mfma_f32_16x16x32_bf16 v[56:59], v[208:211], v[176:179], v[56:59]
v_mfma_f32_16x16x32_bf16 v[60:63], v[212:215], v[168:171], v[60:63]
s_add_u32 m0, s33, 16384
s_nop 0
buffer_load_dwordx4 v241, s[12:15], s31 offen lds
v_mfma_f32_16x16x32_bf16 v[64:67], v[212:215], v[172:175], v[64:67]
v_mfma_f32_16x16x32_bf16 v[68:71], v[212:215], v[176:179], v[68:71]
v_mfma_f32_16x16x32_bf16 v[72:75], v[216:219], v[168:171], v[72:75]
v_mfma_f32_16x16x32_bf16 v[76:79], v[216:219], v[172:175], v[76:79]
v_mfma_f32_16x16x32_bf16 v[80:83], v[216:219], v[176:179], v[80:83]
s_add_u32 m0, s33, 17408
s_add_u32 s38, s31, 4096
buffer_load_dwordx4 v242, s[12:15], s38 offen lds
v_mfma_f32_16x16x32_bf16 v[84:87], v[220:223], v[168:171], v[84:87]
v_mfma_f32_16x16x32_bf16 v[88:91], v[220:223], v[172:175], v[88:91]
v_mfma_f32_16x16x32_bf16 v[92:95], v[220:223], v[176:179], v[92:95]
s_waitcnt lgkmcnt(0)
ds_read_b64_tr_b16 v[208:209], v236 offset:49152
ds_read_b64_tr_b16 v[210:211], v236 offset:53248
ds_read_b64_tr_b16 v[212:213], v237 offset:49152
ds_read_b64_tr_b16 v[214:215], v237 offset:53248
ds_read_b64_tr_b16 v[216:217], v238 offset:49152
ds_read_b64_tr_b16 v[218:219], v238 offset:53248
ds_read_b64_tr_b16 v[220:221], v239 offset:49152
ds_read_b64_tr_b16 v[222:223], v239 offset:53248
v_mfma_f32_16x16x32_bf16 v[0:3], v[192:195], v[180:183], v[0:3]
v_mfma_f32_16x16x32_bf16 v[4:7], v[192:195], v[184:187], v[4:7]
buffer_load_dwordx4 v[108:111], v240, s[8:11], s30 offen
v_mfma_f32_16x16x32_bf16 v[8:11], v[192:195], v[188:191], v[8:11]
v_mfma_f32_16x16x32_bf16 v[12:15], v[196:199], v[180:183], v[12:15]
v_mfma_f32_16x16x32_bf16 v[16:19], v[196:199], v[184:187], v[16:19]
v_mfma_f32_16x16x32_bf16 v[20:23], v[196:199], v[188:191], v[20:23]
s_add_u32 s38, s30, 4096
buffer_load_dwordx4 v[112:115], v240, s[8:11], s38 offen
v_mfma_f32_16x16x32_bf16 v[24:27], v[200:203], v[180:183], v[24:27]
v_mfma_f32_16x16x32_bf16 v[28:31], v[200:203], v[184:187], v[28:31]
v_mfma_f32_16x16x32_bf16 v[32:35], v[200:203], v[188:191], v[32:35]
v_mfma_f32_16x16x32_bf16 v[36:39], v[204:207], v[180:183], v[36:39]
s_add_u32 s38, s30, 8192
buffer_load_dwordx4 v[116:119], v240, s[8:11], s38 offen
s_add_u32 s30, s30, 47104
s_add_u32 s31, s31, 65536
s_add_u32 s60, s60, 2
s_cmp_eq_u32 s60, 16
s_cselect_b32 s61, 393216, 0
s_sub_u32 s30, s30, s61
s_cmp_eq_u32 s60, 16
s_cselect_b32 s61, 0x100000, 0
s_sub_u32 s31, s31, s61
v_mfma_f32_16x16x32_bf16 v[40:43], v[204:207], v[184:187], v[40:43]
v_mfma_f32_16x16x32_bf16 v[44:47], v[204:207], v[188:191], v[44:47]
s_waitcnt vmcnt(5) lgkmcnt(0)
s_barrier
ds_read_b64_tr_b16 v[192:193], v224 offset:0
ds_read_b64_tr_b16 v[194:195], v224 offset:4096
ds_read_b64_tr_b16 v[196:197], v225 offset:0
ds_read_b64_tr_b16 v[198:199], v225 offset:4096
ds_read_b64_tr_b16 v[200:201], v226 offset:0
ds_read_b64_tr_b16 v[202:203], v226 offset:4096
ds_read_b64_tr_b16 v[204:205], v227 offset:0
ds_read_b64_tr_b16 v[206:207], v227 offset:4096
v_mfma_f32_16x16x32_bf16 v[48:51], v[208:211], v[180:183], v[48:51]
v_mfma_f32_16x16x32_bf16 v[52:55], v[208:211], v[184:187], v[52:55]
v_mfma_f32_16x16x32_bf16 v[56:59], v[208:211], v[188:191], v[56:59]
v_mfma_f32_16x16x32_bf16 v[60:63], v[212:215], v[180:183], v[60:63]
s_add_u32 m0, s33, 32768
s_nop 0
buffer_load_dwordx4 v241, s[12:15], s31 offen lds
v_mfma_f32_16x16x32_bf16 v[64:67], v[212:215], v[184:187], v[64:67]
v_mfma_f32_16x16x32_bf16 v[68:71], v[212:215], v[188:191], v[68:71]
v_mfma_f32_16x16x32_bf16 v[72:75], v[216:219], v[180:183], v[72:75]
v_mfma_f32_16x16x32_bf16 v[76:79], v[216:219], v[184:187], v[76:79]
v_mfma_f32_16x16x32_bf16 v[80:83], v[216:219], v[188:191], v[80:83]
s_add_u32 m0, s33, 33792
s_add_u32 s38, s31, 4096
buffer_load_dwordx4 v242, s[12:15], s38 offen lds
v_mfma_f32_16x16x32_bf16 v[84:87], v[220:223], v[180:183], v[84:87]
v_mfma_f32_16x16x32_bf16 v[88:91], v[220:223], v[184:187], v[88:91]
v_mfma_f32_16x16x32_bf16 v[92:95], v[220:223], v[188:191], v[92:95]
s_waitcnt lgkmcnt(0)
ds_read_b64_tr_b16 v[208:209], v228 offset:0
ds_read_b64_tr_b16 v[210:211], v228 offset:4096
ds_read_b64_tr_b16 v[212:213], v229 offset:0
ds_read_b64_tr_b16 v[214:215], v229 offset:4096
ds_read_b64_tr_b16 v[216:217], v230 offset:0
ds_read_b64_tr_b16 v[218:219], v230 offset:4096
ds_read_b64_tr_b16 v[220:221], v231 offset:0
ds_read_b64_tr_b16 v[222:223], v231 offset:4096
v_mfma_f32_16x16x32_bf16 v[0:3], v[192:195], v[96:99], v[0:3]
v_mfma_f32_16x16x32_bf16 v[4:7], v[192:195], v[100:103], v[4:7]
buffer_load_dwordx4 v[120:123], v240, s[8:11], s30 offen
v_mfma_f32_16x16x32_bf16 v[8:11], v[192:195], v[104:107], v[8:11]
v_mfma_f32_16x16x32_bf16 v[12:15], v[196:199], v[96:99], v[12:15]
v_mfma_f32_16x16x32_bf16 v[16:19], v[196:199], v[100:103], v[16:19]
v_mfma_f32_16x16x32_bf16 v[20:23], v[196:199], v[104:107], v[20:23]
s_add_u32 s38, s30, 4096
buffer_load_dwordx4 v[124:127], v240, s[8:11], s38 offen
v_mfma_f32_16x16x32_bf16 v[24:27], v[200:203], v[96:99], v[24:27]
v_mfma_f32_16x16x32_bf16 v[28:31], v[200:203], v[100:103], v[28:31]
v_mfma_f32_16x16x32_bf16 v[32:35], v[200:203], v[104:107], v[32:35]
v_mfma_f32_16x16x32_bf16 v[36:39], v[204:207], v[96:99], v[36:39]
s_add_u32 s38, s30, 8192
buffer_load_dwordx4 v[128:131], v240, s[8:11], s38 offen
s_add_u32 s30, s30, 2048
s_add_u32 s31, s31, 65536
v_mfma_f32_16x16x32_bf16 v[40:43], v[204:207], v[100:103], v[40:43]
v_mfma_f32_16x16x32_bf16 v[44:47], v[204:207], v[104:107], v[44:47]
s_waitcnt vmcnt(5) lgkmcnt(0)
s_barrier
ds_read_b64_tr_b16 v[192:193], v224 offset:16384
ds_read_b64_tr_b16 v[194:195], v224 offset:20480
ds_read_b64_tr_b16 v[196:197], v225 offset:16384
ds_read_b64_tr_b16 v[198:199], v225 offset:20480
ds_read_b64_tr_b16 v[200:201], v226 offset:16384
ds_read_b64_tr_b16 v[202:203], v226 offset:20480
ds_read_b64_tr_b16 v[204:205], v227 offset:16384
ds_read_b64_tr_b16 v[206:207], v227 offset:20480
v_mfma_f32_16x16x32_bf16 v[48:51], v[208:211], v[96:99], v[48:51]
v_mfma_f32_16x16x32_bf16 v[52:55], v[208:211], v[100:103], v[52:55]
v_mfma_f32_16x16x32_bf16 v[56:59], v[208:211], v[104:107], v[56:59]
v_mfma_f32_16x16x32_bf16 v[60:63], v[212:215], v[96:99], v[60:63]
s_add_u32 m0, s33, 49152
s_nop 0
buffer_load_dwordx4 v241, s[12:15], s31 offen lds
v_mfma_f32_16x16x32_bf16 v[64:67], v[212:215], v[100:103], v[64:67]
v_mfma_f32_16x16x32_bf16 v[68:71], v[212:215], v[104:107], v[68:71]
v_mfma_f32_16x16x32_bf16 v[72:75], v[216:219], v[96:99], v[72:75]
v_mfma_f32_16x16x32_bf16 v[76:79], v[216:219], v[100:103], v[76:79]
v_mfma_f32_16x16x32_bf16 v[80:83], v[216:219], v[104:107], v[80:83]
s_add_u32 m0, s33, 50176
s_add_u32 s38, s31, 4096
buffer_load_dwordx4 v242, s[12:15], s38 offen lds
v_mfma_f32_16x16x32_bf16 v[84:87], v[220:223], v[96:99], v[84:87]
v_mfma_f32_16x16x32_bf16 v[88:91], v[220:223], v[100:103], v[88:91]
v_mfma_f32_16x16x32_bf16 v[92:95], v[220:223], v[104:107], v[92:95]
s_waitcnt lgkmcnt(0)
ds_read_b64_tr_b16 v[208:209], v228 offset:16384
ds_read_b64_tr_b16 v[210:211], v228 offset:20480
ds_read_b64_tr_b16 v[212:213], v229 offset:16384
ds_read_b64_tr_b16 v[214:215], v229 offset:20480
ds_read_b64_tr_b16 v[216:217], v230 offset:16384
ds_read_b64_tr_b16 v[218:219], v230 offset:20480
ds_read_b64_tr_b16 v[220:221], v231 offset:16384
ds_read_b64_tr_b16 v[222:223], v231 offset:20480
v_mfma_f32_16x16x32_bf16 v[0:3], v[192:195], v[108:111], v[0:3]
v_mfma_f32_16x16x32_bf16 v[4:7], v[192:195], v[112:115], v[4:7]
buffer_load_dwordx4 v[132:135], v240, s[8:11], s30 offen
v_mfma_f32_16x16x32_bf16 v[8:11], v[192:195], v[116:119], v[8:11]
v_mfma_f32_16x16x32_bf16 v[12:15], v[196:199], v[108:111], v[12:15]
v_mfma_f32_16x16x32_bf16 v[16:19], v[196:199], v[112:115], v[16:19]
v_mfma_f32_16x16x32_bf16 v[20:23], v[196:199], v[116:119], v[20:23]
s_add_u32 s38, s30, 4096
buffer_load_dwordx4 v[136:139], v240, s[8:11], s38 offen
v_mfma_f32_16x16x32_bf16 v[24:27], v[200:203], v[108:111], v[24:27]
v_mfma_f32_16x16x32_bf16 v[28:31], v[200:203], v[112:115], v[28:31]
v_mfma_f32_16x16x32_bf16 v[32:35], v[200:203], v[116:119], v[32:35]
v_mfma_f32_16x16x32_bf16 v[36:39], v[204:207], v[108:111], v[36:39]
s_add_u32 s38, s30, 8192
buffer_load_dwordx4 v[140:143], v240, s[8:11], s38 offen
s_add_u32 s30, s30, 47104
s_add_u32 s31, s31, 65536
s_add_u32 s60, s60, 2
s_cmp_eq_u32 s60, 16
s_cselect_b32 s61, 393216, 0
s_sub_u32 s30, s30, s61
s_cmp_eq_u32 s60, 16
s_cselect_b32 s61, 0x100000, 0
s_sub_u32 s31, s31, s61
v_mfma_f32_16x16x32_bf16 v[40:43], v[204:207], v[112:115], v[40:43]
v_mfma_f32_16x16x32_bf16 v[44:47], v[204:207], v[116:119], v[44:47]
s_waitcnt vmcnt(5) lgkmcnt(0)
s_barrier
ds_read_b64_tr_b16 v[192:193], v224 offset:32768
ds_read_b64_tr_b16 v[194:195], v224 offset:36864
ds_read_b64_tr_b16 v[196:197], v225 offset:32768
ds_read_b64_tr_b16 v[198:199], v225 offset:36864
ds_read_b64_tr_b16 v[200:201], v226 offset:32768
ds_read_b64_tr_b16 v[202:203], v226 offset:36864
ds_read_b64_tr_b16 v[204:205], v227 offset:32768
ds_read_b64_tr_b16 v[206:207], v227 offset:36864
v_mfma_f32_16x16x32_bf16 v[48:51], v[208:211], v[108:111], v[48:51]
v_mfma_f32_16x16x32_bf16 v[52:55], v[208:211], v[112:115], v[52:55]
v_mfma_f32_16x16x32_bf16 v[56:59], v[208:211], v[116:119], v[56:59]
v_mfma_f32_16x16x32_bf16 v[60:63], v[212:215], v[108:111], v[60:63]
s_add_u32 m0, s33, 65536
s_nop 0
buffer_load_dwordx4 v241, s[12:15], s31 offen lds
v_mfma_f32_16x16x32_bf16 v[64:67], v[212:215], v[112:115], v[64:67]
v_mfma_f32_16x16x32_bf16 v[68:71], v[212:215], v[116:119], v[68:71]
v_mfma_f32_16x16x32_bf16 v[72:75], v[216:219], v[108:111], v[72:75]
v_mfma_f32_16x16x32_bf16 v[76:79], v[216:219], v[112:115], v[76:79]
v_mfma_f32_16x16x32_bf16 v[80:83], v[216:219], v[116:119], v[80:83]
s_add_u32 m0, s33, 66560
s_add_u32 s38, s31, 4096
buffer_load_dwordx4 v242, s[12:15], s38 offen lds
v_mfma_f32_16x16x32_bf16 v[84:87], v[220:223], v[108:111], v[84:87]
v_mfma_f32_16x16x32_bf16 v[88:91], v[220:223], v[112:115], v[88:91]
v_mfma_f32_16x16x32_bf16 v[92:95], v[220:223], v[116:119], v[92:95]
s_waitcnt lgkmcnt(0)
ds_read_b64_tr_b16 v[208:209], v228 offset:32768
ds_read_b64_tr_b16 v[210:211], v228 offset:36864
ds_read_b64_tr_b16 v[212:213], v229 offset:32768
ds_read_b64_tr_b16 v[214:215], v229 offset:36864
ds_read_b64_tr_b16 v[216:217], v230 offset:32768
ds_read_b64_tr_b16 v[218:219], v230 offset:36864
ds_read_b64_tr_b16 v[220:221], v231 offset:32768
ds_read_b64_tr_b16 v[222:223], v231 offset:36864
v_mfma_f32_16x16x32_bf16 v[0:3], v[192:195], v[120:123], v[0:3]
v_mfma_f32_16x16x32_bf16 v[4:7], v[192:195], v[124:127], v[4:7]
buffer_load_dwordx4 v[144:147], v240, s[8:11], s30 offen
v_mfma_f32_16x16x32_bf16 v[8:11], v[192:195], v[128:131], v[8:11]
v_mfma_f32_16x16x32_bf16 v[12:15], v[196:199], v[120:123], v[12:15]
v_mfma_f32_16x16x32_bf16 v[16:19], v[196:199], v[124:127], v[16:19]
v_mfma_f32_16x16x32_bf16 v[20:23], v[196:199], v[128:131], v[20:23]
s_add_u32 s38, s30, 4096
buffer_load_dwordx4 v[148:151], v240, s[8:11], s38 offen
v_mfma_f32_16x16x32_bf16 v[24:27], v[200:203], v[120:123], v[24:27]
v_mfma_f32_16x16x32_bf16 v[28:31], v[200:203], v[124:127], v[28:31]
v_mfma_f32_16x16x32_bf16 v[32:35], v[200:203], v[128:131], v[32:35]
v_mfma_f32_16x16x32_bf16 v[36:39], v[204:207], v[120:123], v[36:39]
s_add_u32 s38, s30, 8192
buffer_load_dwordx4 v[152:155], v240, s[8:11], s38 offen
s_add_u32 s30, s30, 2048
s_add_u32 s31, s31, 65536
v_mfma_f32_16x16x32_bf16 v[40:43], v[204:207], v[124:127], v[40:43]
v_mfma_f32_16x16x32_bf16 v[44:47], v[204:207], v[128:131], v[44:47]
s_waitcnt vmcnt(5) lgkmcnt(0)
s_barrier
ds_read_b64_tr_b16 v[192:193], v224 offset:49152
ds_read_b64_tr_b16 v[194:195], v224 offset:53248
ds_read_b64_tr_b16 v[196:197], v225 offset:49152
ds_read_b64_tr_b16 v[198:199], v225 offset:53248
ds_read_b64_tr_b16 v[200:201], v226 offset:49152
ds_read_b64_tr_b16 v[202:203], v226 offset:53248
ds_read_b64_tr_b16 v[204:205], v227 offset:49152
ds_read_b64_tr_b16 v[206:207], v227 offset:53248
v_mfma_f32_16x16x32_bf16 v[48:51], v[208:211], v[120:123], v[48:51]
v_mfma_f32_16x16x32_bf16 v[52:55], v[208:211], v[124:127], v[52:55]
v_mfma_f32_16x16x32_bf16 v[56:59], v[208:211], v[128:131], v[56:59]
v_mfma_f32_16x16x32_bf16 v[60:63], v[212:215], v[120:123], v[60:63]
s_add_u32 m0, s33, 81920
s_nop 0
buffer_load_dwordx4 v241, s[12:15], s31 offen lds
v_mfma_f32_16x16x32_bf16 v[64:67], v[212:215], v[124:127], v[64:67]
v_mfma_f32_16x16x32_bf16 v[68:71], v[212:215], v[128:131], v[68:71]
v_mfma_f32_16x16x32_bf16 v[72:75], v[216:219], v[120:123], v[72:75]
v_mfma_f32_16x16x32_bf16 v[76:79], v[216:219], v[124:127], v[76:79]
v_mfma_f32_16x16x32_bf16 v[80:83], v[216:219], v[128:131], v[80:83]
s_add_u32 m0, s33, 82944
s_add_u32 s38, s31, 4096
buffer_load_dwordx4 v242, s[12:15], s38 offen lds
v_mfma_f32_16x16x32_bf16 v[84:87], v[220:223], v[120:123], v[84:87]
v_mfma_f32_16x16x32_bf16 v[88:91], v[220:223], v[124:127], v[88:91]
v_mfma_f32_16x16x32_bf16 v[92:95], v[220:223], v[128:131], v[92:95]
s_waitcnt lgkmcnt(0)
ds_read_b64_tr_b16 v[208:209], v228 offset:49152
ds_read_b64_tr_b16 v[210:211], v228 offset:53248
ds_read_b64_tr_b16 v[212:213], v229 offset:49152
ds_read_b64_tr_b16 v[214:215], v229 offset:53248
ds_read_b64_tr_b16 v[216:217], v230 offset:49152
ds_read_b64_tr_b16 v[218:219], v230 offset:53248
ds_read_b64_tr_b16 v[220:221], v231 offset:49152
ds_read_b64_tr_b16 v[222:223], v231 offset:53248
v_mfma_f32_16x16x32_bf16 v[0:3], v[192:195], v[132:135], v[0:3]
v_mfma_f32_16x16x32_bf16 v[4:7], v[192:195], v[136:139], v[4:7]
buffer_load_dwordx4 v[156:159], v240, s[8:11], s30 offen
v_mfma_f32_16x16x32_bf16 v[8:11], v[192:195], v[140:143], v[8:11]
v_mfma_f32_16x16x32_bf16 v[12:15], v[196:199], v[132:135], v[12:15]
v_mfma_f32_16x16x32_bf16 v[16:19], v[196:199], v[136:139], v[16:19]
v_mfma_f32_16x16x32_bf16 v[20:23], v[196:199], v[140:143], v[20:23]
s_add_u32 s38, s30, 4096
buffer_load_dwordx4 v[160:163], v240, s[8:11], s38 offen
v_mfma_f32_16x16x32_bf16 v[24:27], v[200:203], v[132:135], v[24:27]
v_mfma_f32_16x16x32_bf16 v[28:31], v[200:203], v[136:139], v[28:31]
v_mfma_f32_16x16x32_bf16 v[32:35], v[200:203], v[140:143], v[32:35]
v_mfma_f32_16x16x32_bf16 v[36:39], v[204:207], v[132:135], v[36:39]
s_add_u32 s38, s30, 8192
buffer_load_dwordx4 v[164:167], v240, s[8:11], s38 offen
s_add_u32 s30, s30, 47104
s_add_u32 s31, s31, 65536
s_add_u32 s60, s60, 2
s_cmp_eq_u32 s60, 16
s_cselect_b32 s61, 393216, 0
s_sub_u32 s30, s30, s61
s_cmp_eq_u32 s60, 16
s_cselect_b32 s61, 0x100000, 0
s_sub_u32 s31, s31, s61
v_mfma_f32_16x16x32_bf16 v[40:43], v[204:207], v[136:139], v[40:43]
v_mfma_f32_16x16x32_bf16 v[44:47], v[204:207], v[140:143], v[44:47]
s_waitcnt vmcnt(5) lgkmcnt(0)
s_barrier
ds_read_b64_tr_b16 v[192:193], v232 offset:0
ds_read_b64_tr_b16 v[194:195], v232 offset:4096
ds_read_b64_tr_b16 v[196:197], v233 offset:0
ds_read_b64_tr_b16 v[198:199], v233 offset:4096
ds_read_b64_tr_b16 v[200:201], v234 offset:0
ds_read_b64_tr_b16 v[202:203], v234 offset:4096
ds_read_b64_tr_b16 v[204:205], v235 offset:0
ds_read_b64_tr_b16 v[206:207], v235 offset:4096
v_mfma_f32_16x16x32_bf16 v[48:51], v[208:211], v[132:135], v[48:51]
v_mfma_f32_16x16x32_bf16 v[52:55], v[208:211], v[136:139], v[52:55]
v_mfma_f32_16x16x32_bf16 v[56:59], v[208:211], v[140:143], v[56:59]
v_mfma_f32_16x16x32_bf16 v[60:63], v[212:215], v[132:135], v[60:63]
s_add_u32 m0, s33, 98304
s_nop 0
buffer_load_dwordx4 v241, s[12:15], s31 offen lds
v_mfma_f32_16x16x32_bf16 v[64:67], v[212:215], v[136:139], v[64:67]
v_mfma_f32_16x16x32_bf16 v[68:71], v[212:215], v[140:143], v[68:71]
v_mfma_f32_16x16x32_bf16 v[72:75], v[216:219], v[132:135], v[72:75]
v_mfma_f32_16x16x32_bf16 v[76:79], v[216:219], v[136:139], v[76:79]
v_mfma_f32_16x16x32_bf16 v[80:83], v[216:219], v[140:143], v[80:83]
s_add_u32 m0, s33, 99328
s_add_u32 s38, s31, 4096
buffer_load_dwordx4 v242, s[12:15], s38 offen lds
v_mfma_f32_16x16x32_bf16 v[84:87], v[220:223], v[132:135], v[84:87]
v_mfma_f32_16x16x32_bf16 v[88:91], v[220:223], v[136:139], v[88:91]
v_mfma_f32_16x16x32_bf16 v[92:95], v[220:223], v[140:143], v[92:95]
s_waitcnt lgkmcnt(0)
ds_read_b64_tr_b16 v[208:209], v236 offset:0
ds_read_b64_tr_b16 v[210:211], v236 offset:4096
ds_read_b64_tr_b16 v[212:213], v237 offset:0
ds_read_b64_tr_b16 v[214:215], v237 offset:4096
ds_read_b64_tr_b16 v[216:217], v238 offset:0
ds_read_b64_tr_b16 v[218:219], v238 offset:4096
ds_read_b64_tr_b16 v[220:221], v239 offset:0
ds_read_b64_tr_b16 v[222:223], v239 offset:4096
v_mfma_f32_16x16x32_bf16 v[0:3], v[192:195], v[144:147], v[0:3]
v_mfma_f32_16x16x32_bf16 v[4:7], v[192:195], v[148:151], v[4:7]
buffer_load_dwordx4 v[168:171], v240, s[8:11], s30 offen
v_mfma_f32_16x16x32_bf16 v[8:11], v[192:195], v[152:155], v[8:11]
v_mfma_f32_16x16x32_bf16 v[12:15], v[196:199], v[144:147], v[12:15]
v_mfma_f32_16x16x32_bf16 v[16:19], v[196:199], v[148:151], v[16:19]
v_mfma_f32_16x16x32_bf16 v[20:23], v[196:199], v[152:155], v[20:23]
s_add_u32 s38, s30, 4096
buffer_load_dwordx4 v[172:175], v240, s[8:11], s38 offen
v_mfma_f32_16x16x32_bf16 v[24:27], v[200:203], v[144:147], v[24:27]
v_mfma_f32_16x16x32_bf16 v[28:31], v[200:203], v[148:151], v[28:31]
v_mfma_f32_16x16x32_bf16 v[32:35], v[200:203], v[152:155], v[32:35]
v_mfma_f32_16x16x32_bf16 v[36:39], v[204:207], v[144:147], v[36:39]
s_add_u32 s38, s30, 8192
buffer_load_dwordx4 v[176:179], v240, s[8:11], s38 offen
s_add_u32 s30, s30, 2048
s_add_u32 s31, s31, 65536
v_mfma_f32_16x16x32_bf16 v[40:43], v[204:207], v[148:151], v[40:43]
v_mfma_f32_16x16x32_bf16 v[44:47], v[204:207], v[152:155], v[44:47]
s_waitcnt vmcnt(5) lgkmcnt(0)
s_barrier
ds_read_b64_tr_b16 v[192:193], v232 offset:16384
ds_read_b64_tr_b16 v[194:195], v232 offset:20480
ds_read_b64_tr_b16 v[196:197], v233 offset:16384
ds_read_b64_tr_b16 v[198:199], v233 offset:20480
ds_read_b64_tr_b16 v[200:201], v234 offset:16384
ds_read_b64_tr_b16 v[202:203], v234 offset:20480
ds_read_b64_tr_b16 v[204:205], v235 offset:16384
ds_read_b64_tr_b16 v[206:207], v235 offset:20480
v_mfma_f32_16x16x32_bf16 v[48:51], v[208:211], v[144:147], v[48:51]
v_mfma_f32_16x16x32_bf16 v[52:55], v[208:211], v[148:151], v[52:55]
v_mfma_f32_16x16x32_bf16 v[56:59], v[208:211], v[152:155], v[56:59]
v_mfma_f32_16x16x32_bf16 v[60:63], v[212:215], v[144:147], v[60:63]
s_add_u32 m0, s33, 114688
s_nop 0
buffer_load_dwordx4 v241, s[12:15], s31 offen lds
v_mfma_f32_16x16x32_bf16 v[64:67], v[212:215], v[148:151], v[64:67]
v_mfma_f32_16x16x32_bf16 v[68:71], v[212:215], v[152:155], v[68:71]
v_mfma_f32_16x16x32_bf16 v[72:75], v[216:219], v[144:147], v[72:75]
v_mfma_f32_16x16x32_bf16 v[76:79], v[216:219], v[148:151], v[76:79]
v_mfma_f32_16x16x32_bf16 v[80:83], v[216:219], v[152:155], v[80:83]
s_add_u32 m0, s33, 115712
s_add_u32 s38, s31, 4096
buffer_load_dwordx4 v242, s[12:15], s38 offen lds
v_mfma_f32_16x16x32_bf16 v[84:87], v[220:223], v[144:147], v[84:87]
v_mfma_f32_16x16x32_bf16 v[88:91], v[220:223], v[148:151], v[88:91]
v_mfma_f32_16x16x32_bf16 v[92:95], v[220:223], v[152:155], v[92:95]
s_waitcnt lgkmcnt(0)
ds_read_b64_tr_b16 v[208:209], v236 offset:16384
ds_read_b64_tr_b16 v[210:211], v236 offset:20480
ds_read_b64_tr_b16 v[212:213], v237 offset:16384
ds_read_b64_tr_b16 v[214:215], v237 offset:20480
ds_read_b64_tr_b16 v[216:217], v238 offset:16384
ds_read_b64_tr_b16 v[218:219], v238 offset:20480
ds_read_b64_tr_b16 v[220:221], v239 offset:16384
ds_read_b64_tr_b16 v[222:223], v239 offset:20480
v_mfma_f32_16x16x32_bf16 v[0:3], v[192:195], v[156:159], v[0:3]
v_mfma_f32_16x16x32_bf16 v[4:7], v[192:195], v[160:163], v[4:7]
buffer_load_dwordx4 v[180:183], v240, s[8:11], s30 offen
v_mfma_f32_16x16x32_bf16 v[8:11], v[192:195], v[164:167], v[8:11]
v_mfma_f32_16x16x32_bf16 v[12:15], v[196:199], v[156:159], v[12:15]
v_mfma_f32_16x16x32_bf16 v[16:19], v[196:199], v[160:163], v[16:19]
v_mfma_f32_16x16x32_bf16 v[20:23], v[196:199], v[164:167], v[20:23]
s_add_u32 s38, s30, 4096
buffer_load_dwordx4 v[184:187], v240, s[8:11], s38 offen
v_mfma_f32_16x16x32_bf16 v[24:27], v[200:203], v[156:159], v[24:27]
v_mfma_f32_16x16x32_bf16 v[28:31], v[200:203], v[160:163], v[28:31]
v_mfma_f32_16x16x32_bf16 v[32:35], v[200:203], v[164:167], v[32:35]
v_mfma_f32_16x16x32_bf16 v[36:39], v[204:207], v[156:159], v[36:39]
s_add_u32 s38, s30, 8192
buffer_load_dwordx4 v[188:191], v240, s[8:11], s38 offen
s_add_u32 s30, s30, 47104
s_add_u32 s31, s31, 65536
s_add_u32 s60, s60, 2
s_cmp_eq_u32 s60, 16
s_cselect_b32 s61, 393216, 0
s_sub_u32 s30, s30, s61
s_cmp_eq_u32 s60, 16
s_cselect_b32 s61, 0x100000, 0
s_sub_u32 s31, s31, s61
v_mfma_f32_16x16x32_bf16 v[40:43], v[204:207], v[160:163], v[40:43]
v_mfma_f32_16x16x32_bf16 v[44:47], v[204:207], v[164:167], v[44:47]
s_waitcnt vmcnt(5) lgkmcnt(0)
s_barrier
ds_read_b64_tr_b16 v[192:193], v232 offset:32768
ds_read_b64_tr_b16 v[194:195], v232 offset:36864
ds_read_b64_tr_b16 v[196:197], v233 offset:32768
ds_read_b64_tr_b16 v[198:199], v233 offset:36864
ds_read_b64_tr_b16 v[200:201], v234 offset:32768
ds_read_b64_tr_b16 v[202:203], v234 offset:36864
ds_read_b64_tr_b16 v[204:205], v235 offset:32768
ds_read_b64_tr_b16 v[206:207], v235 offset:36864
v_mfma_f32_16x16x32_bf16 v[48:51], v[208:211], v[156:159], v[48:51]
v_mfma_f32_16x16x32_bf16 v[52:55], v[208:211], v[160:163], v[52:55]
v_mfma_f32_16x16x32_bf16 v[56:59], v[208:211], v[164:167], v[56:59]
v_mfma_f32_16x16x32_bf16 v[60:63], v[212:215], v[156:159], v[60:63]
v_mfma_f32_16x16x32_bf16 v[64:67], v[212:215], v[160:163], v[64:67]
v_mfma_f32_16x16x32_bf16 v[68:71], v[212:215], v[164:167], v[68:71]
v_mfma_f32_16x16x32_bf16 v[72:75], v[216:219], v[156:159], v[72:75]
v_mfma_f32_16x16x32_bf16 v[76:79], v[216:219], v[160:163], v[76:79]
v_mfma_f32_16x16x32_bf16 v[80:83], v[216:219], v[164:167], v[80:83]
v_mfma_f32_16x16x32_bf16 v[84:87], v[220:223], v[156:159], v[84:87]
v_mfma_f32_16x16x32_bf16 v[88:91], v[220:223], v[160:163], v[88:91]
v_mfma_f32_16x16x32_bf16 v[92:95], v[220:223], v[164:167], v[92:95]
s_waitcnt lgkmcnt(0)
ds_read_b64_tr_b16 v[208:209], v236 offset:32768
ds_read_b64_tr_b16 v[210:211], v236 offset:36864
ds_read_b64_tr_b16 v[212:213], v237 offset:32768
ds_read_b64_tr_b16 v[214:215], v237 offset:36864
ds_read_b64_tr_b16 v[216:217], v238 offset:32768
ds_read_b64_tr_b16 v[218:219], v238 offset:36864
ds_read_b64_tr_b16 v[220:221], v239 offset:32768
ds_read_b64_tr_b16 v[222:223], v239 offset:36864
v_mfma_f32_16x16x32_bf16 v[0:3], v[192:195], v[168:171], v[0:3]
v_mfma_f32_16x16x32_bf16 v[4:7], v[192:195], v[172:175], v[4:7]
v_mfma_f32_16x16x32_bf16 v[8:11], v[192:195], v[176:179], v[8:11]
v_mfma_f32_16x16x32_bf16 v[12:15], v[196:199], v[168:171], v[12:15]
v_mfma_f32_16x16x32_bf16 v[16:19], v[196:199], v[172:175], v[16:19]
v_mfma_f32_16x16x32_bf16 v[20:23], v[196:199], v[176:179], v[20:23]
v_mfma_f32_16x16x32_bf16 v[24:27], v[200:203], v[168:171], v[24:27]
v_mfma_f32_16x16x32_bf16 v[28:31], v[200:203], v[172:175], v[28:31]
v_mfma_f32_16x16x32_bf16 v[32:35], v[200:203], v[176:179], v[32:35]
v_mfma_f32_16x16x32_bf16 v[36:39], v[204:207], v[168:171], v[36:39]
v_mfma_f32_16x16x32_bf16 v[40:43], v[204:207], v[172:175], v[40:43]
v_mfma_f32_16x16x32_bf16 v[44:47], v[204:207], v[176:179], v[44:47]
s_waitcnt vmcnt(0) lgkmcnt(0)
s_barrier
ds_read_b64_tr_b16 v[192:193], v232 offset:49152
ds_read_b64_tr_b16 v[194:195], v232 offset:53248
ds_read_b64_tr_b16 v[196:197], v233 offset:49152
ds_read_b64_tr_b16 v[198:199], v233 offset:53248
ds_read_b64_tr_b16 v[200:201], v234 offset:49152
ds_read_b64_tr_b16 v[202:203], v234 offset:53248
ds_read_b64_tr_b16 v[204:205], v235 offset:49152
ds_read_b64_tr_b16 v[206:207], v235 offset:53248
v_mfma_f32_16x16x32_bf16 v[48:51], v[208:211], v[168:171], v[48:51]
v_mfma_f32_16x16x32_bf16 v[52:55], v[208:211], v[172:175], v[52:55]
v_mfma_f32_16x16x32_bf16 v[56:59], v[208:211], v[176:179], v[56:59]
v_mfma_f32_16x16x32_bf16 v[60:63], v[212:215], v[168:171], v[60:63]
v_mfma_f32_16x16x32_bf16 v[64:67], v[212:215], v[172:175], v[64:67]
v_mfma_f32_16x16x32_bf16 v[68:71], v[212:215], v[176:179], v[68:71]
v_mfma_f32_16x16x32_bf16 v[72:75], v[216:219], v[168:171], v[72:75]
v_mfma_f32_16x16x32_bf16 v[76:79], v[216:219], v[172:175], v[76:79]
v_mfma_f32_16x16x32_bf16 v[80:83], v[216:219], v[176:179], v[80:83]
v_mfma_f32_16x16x32_bf16 v[84:87], v[220:223], v[168:171], v[84:87]
v_mfma_f32_16x16x32_bf16 v[88:91], v[220:223], v[172:175], v[88:91]
v_mfma_f32_16x16x32_bf16 v[92:95], v[220:223], v[176:179], v[92:95]
s_waitcnt lgkmcnt(0)
ds_read_b64_tr_b16 v[208:209], v236 offset:49152
ds_read_b64_tr_b16 v[210:211], v236 offset:53248
ds_read_b64_tr_b16 v[212:213], v237 offset:49152
ds_read_b64_tr_b16 v[214:215], v237 offset:53248
ds_read_b64_tr_b16 v[216:217], v238 offset:49152
ds_read_b64_tr_b16 v[218:219], v238 offset:53248
ds_read_b64_tr_b16 v[220:221], v239 offset:49152
ds_read_b64_tr_b16 v[222:223], v239 offset:53248
v_mfma_f32_16x16x32_bf16 v[0:3], v[192:195], v[180:183], v[0:3]
v_mfma_f32_16x16x32_bf16 v[4:7], v[192:195], v[184:187], v[4:7]
v_mfma_f32_16x16x32_bf16 v[8:11], v[192:195], v[188:191], v[8:11]
v_mfma_f32_16x16x32_bf16 v[12:15], v[196:199], v[180:183], v[12:15]
v_mfma_f32_16x16x32_bf16 v[16:19], v[196:199], v[184:187], v[16:19]
v_mfma_f32_16x16x32_bf16 v[20:23], v[196:199], v[188:191], v[20:23]
v_mfma_f32_16x16x32_bf16 v[24:27], v[200:203], v[180:183], v[24:27]
v_mfma_f32_16x16x32_bf16 v[28:31], v[200:203], v[184:187], v[28:31]
v_mfma_f32_16x16x32_bf16 v[32:35], v[200:203], v[188:191], v[32:35]
v_mfma_f32_16x16x32_bf16 v[36:39], v[204:207], v[180:183], v[36:39]
v_mfma_f32_16x16x32_bf16 v[40:43], v[204:207], v[184:187], v[40:43]
v_mfma_f32_16x16x32_bf16 v[44:47], v[204:207], v[188:191], v[44:47]
s_waitcnt lgkmcnt(0)
v_mfma_f32_16x16x32_bf16 v[48:51], v[208:211], v[180:183], v[48:51]
v_mfma_f32_16x16x32_bf16 v[52:55], v[208:211], v[184:187], v[52:55]
v_mfma_f32_16x16x32_bf16 v[56:59], v[208:211], v[188:191], v[56:59]
v_mfma_f32_16x16x32_bf16 v[60:63], v[212:215], v[180:183], v[60:63]
v_mfma_f32_16x16x32_bf16 v[64:67], v[212:215], v[184:187], v[64:67]
v_mfma_f32_16x16x32_bf16 v[68:71], v[212:215], v[188:191], v[68:71]
v_mfma_f32_16x16x32_bf16 v[72:75], v[216:219], v[180:183], v[72:75]
v_mfma_f32_16x16x32_bf16 v[76:79], v[216:219], v[184:187], v[76:79]
v_mfma_f32_16x16x32_bf16 v[80:83], v[216:219], v[188:191], v[80:83]
v_mfma_f32_16x16x32_bf16 v[84:87], v[220:223], v[180:183], v[84:87]
v_mfma_f32_16x16x32_bf16 v[88:91], v[220:223], v[184:187], v[88:91]
v_mfma_f32_16x16x32_bf16 v[92:95], v[220:223], v[188:191], v[92:95]
s_nop 7
s_cmp_eq_u32 s35, 0
s_cbranch_scc0 K2_KH1
ds_write_b128 v245, v[48:51] offset:0
ds_write_b128 v245, v[52:55] offset:1024
ds_write_b128 v245, v[56:59] offset:2048
ds_write_b128 v245, v[60:63] offset:3072
ds_write_b128 v245, v[64:67] offset:4096
ds_write_b128 v245, v[68:71] offset:5120
ds_write_b128 v245, v[72:75] offset:6144
ds_write_b128 v245, v[76:79] offset:7168
ds_write_b128 v245, v[80:83] offset:8192
ds_write_b128 v245, v[84:87] offset:9216
ds_write_b128 v245, v[88:91] offset:10240
ds_write_b128 v245, v[92:95] offset:11264
s_waitcnt lgkmcnt(0)
s_barrier
ds_read_b128 v[96:99], v246 offset:0
ds_read_b128 v[100:103], v246 offset:1024
ds_read_b128 v[104:107], v246 offset:2048
ds_read_b128 v[108:111], v246 offset:3072
ds_read_b128 v[112:115], v246 offset:4096
ds_read_b128 v[116:119], v246 offset:5120
ds_read_b128 v[120:123], v246 offset:6144
ds_read_b128 v[124:127], v246 offset:7168
ds_read_b128 v[128:131], v246 offset:8192
ds_read_b128 v[132:135], v246 offset:9216
ds_read_b128 v[136:139], v246 offset:10240
ds_read_b128 v[140:143], v246 offset:11264
s_waitcnt lgkmcnt(0)
v_pk_add_f32 v[0:1], v[0:1], v[96:97]
v_pk_add_f32 v[2:3], v[2:3], v[98:99]
v_cvt_pk_bf16_f32 v192, v0, v1
v_cvt_pk_bf16_f32 v193, v2, v3
v_pk_add_f32 v[12:13], v[12:13], v[108:109]
v_pk_add_f32 v[14:15], v[14:15], v[110:111]
v_cvt_pk_bf16_f32 v194, v12, v13
v_cvt_pk_bf16_f32 v195, v14, v15
v_pk_add_f32 v[24:25], v[24:25], v[120:121]
v_pk_add_f32 v[26:27], v[26:27], v[122:123]
v_cvt_pk_bf16_f32 v196, v24, v25
v_cvt_pk_bf16_f32 v197, v26, v27
v_pk_add_f32 v[36:37], v[36:37], v[132:133]
v_pk_add_f32 v[38:39], v[38:39], v[134:135]
v_cvt_pk_bf16_f32 v198, v36, v37
v_cvt_pk_bf16_f32 v199, v38, v39
v_permlane32_swap_b32 v192, v194
v_permlane32_swap_b32 v193, v195
v_permlane32_swap_b32 v196, v198
v_permlane32_swap_b32 v197, v199
v_permlane16_swap_b32 v192, v194
v_permlane16_swap_b32 v193, v195
v_permlane16_swap_b32 v196, v198
v_permlane16_swap_b32 v197, v199
s_mov_b32 s38, 0
buffer_store_dwordx4 v[192:195], v243, s[40:43], s38 offen offset:0 sc0 sc1
buffer_store_dwordx4 v[196:199], v243, s[40:43], s38 offen offset:64 sc0 sc1
v_pk_add_f32 v[4:5], v[4:5], v[100:101]
v_pk_add_f32 v[6:7], v[6:7], v[102:103]
v_cvt_pk_bf16_f32 v200, v4, v5
v_cvt_pk_bf16_f32 v201, v6, v7
v_pk_add_f32 v[16:17], v[16:17], v[112:113]
v_pk_add_f32 v[18:19], v[18:19], v[114:115]
v_cvt_pk_bf16_f32 v202, v16, v17
v_cvt_pk_bf16_f32 v203, v18, v19
v_pk_add_f32 v[28:29], v[28:29], v[124:125]
v_pk_add_f32 v[30:31], v[30:31], v[126:127]
v_cvt_pk_bf16_f32 v204, v28, v29
v_cvt_pk_bf16_f32 v205, v30, v31
v_pk_add_f32 v[40:41], v[40:41], v[136:137]
v_pk_add_f32 v[42:43], v[42:43], v[138:139]
v_cvt_pk_bf16_f32 v206, v40, v41
v_cvt_pk_bf16_f32 v207, v42, v43
v_permlane32_swap_b32 v200, v202
v_permlane32_swap_b32 v201, v203
v_permlane32_swap_b32 v204, v206
v_permlane32_swap_b32 v205, v207
v_permlane16_swap_b32 v200, v202
v_permlane16_swap_b32 v201, v203
v_permlane16_swap_b32 v204, v206
v_permlane16_swap_b32 v205, v207
s_mov_b32 s38, 32768
buffer_store_dwordx4 v[200:203], v243, s[40:43], s38 offen offset:0 sc0 sc1
buffer_store_dwordx4 v[204:207], v243, s[40:43], s38 offen offset:64 sc0 sc1
v_pk_add_f32 v[8:9], v[8:9], v[104:105]
v_pk_add_f32 v[10:11], v[10:11], v[106:107]
v_cvt_pk_bf16_f32 v208, v8, v9
v_cvt_pk_bf16_f32 v209, v10, v11
v_pk_add_f32 v[20:21], v[20:21], v[116:117]
v_pk_add_f32 v[22:23], v[22:23], v[118:119]
v_cvt_pk_bf16_f32 v210, v20, v21
v_cvt_pk_bf16_f32 v211, v22, v23
v_pk_add_f32 v[32:33], v[32:33], v[128:129]
v_pk_add_f32 v[34:35], v[34:35], v[130:131]
v_cvt_pk_bf16_f32 v212, v32, v33
v_cvt_pk_bf16_f32 v213, v34, v35
v_pk_add_f32 v[44:45], v[44:45], v[140:141]
v_pk_add_f32 v[46:47], v[46:47], v[142:143]
v_cvt_pk_bf16_f32 v214, v44, v45
v_cvt_pk_bf16_f32 v215, v46, v47
v_permlane32_swap_b32 v208, v210
v_permlane32_swap_b32 v209, v211
v_permlane32_swap_b32 v212, v214
v_permlane32_swap_b32 v213, v215
v_permlane16_swap_b32 v208, v210
v_permlane16_swap_b32 v209, v211
v_permlane16_swap_b32 v212, v214
v_permlane16_swap_b32 v213, v215
s_mov_b32 s38, 65536
buffer_store_dwordx4 v[208:211], v243, s[40:43], s38 offen offset:0 sc0 sc1
buffer_store_dwordx4 v[212:215], v243, s[40:43], s38 offen offset:64 sc0 sc1
s_branch K2_FIN
K2_KH1:
ds_write_b128 v245, v[0:3] offset:0
ds_write_b128 v245, v[4:7] offset:1024
ds_write_b128 v245, v[8:11] offset:2048
ds_write_b128 v245, v[12:15] offset:3072
ds_write_b128 v245, v[16:19] offset:4096
ds_write_b128 v245, v[20:23] offset:5120
ds_write_b128 v245, v[24:27] offset:6144
ds_write_b128 v245, v[28:31] offset:7168
ds_write_b128 v245, v[32:35] offset:8192
ds_write_b128 v245, v[36:39] offset:9216
ds_write_b128 v245, v[40:43] offset:10240
ds_write_b128 v245, v[44:47] offset:11264
s_waitcnt lgkmcnt(0)
s_barrier
ds_read_b128 v[96:99], v246 offset:0
ds_read_b128 v[100:103], v246 offset:1024
ds_read_b128 v[104:107], v246 offset:2048
ds_read_b128 v[108:111], v246 offset:3072
ds_read_b128 v[112:115], v246 offset:4096
ds_read_b128 v[116:119], v246 offset:5120
ds_read_b128 v[120:123], v246 offset:6144
ds_read_b128 v[124:127], v246 offset:7168
ds_read_b128 v[128:131], v246 offset:8192
ds_read_b128 v[132:135], v246 offset:9216
ds_read_b128 v[136:139], v246 offset:10240
ds_read_b128 v[140:143], v246 offset:11264
s_waitcnt lgkmcnt(0)
v_pk_add_f32 v[48:49], v[48:49], v[96:97]
v_pk_add_f32 v[50:51], v[50:51], v[98:99]
v_cvt_pk_bf16_f32 v192, v48, v49
v_cvt_pk_bf16_f32 v193, v50, v51
v_pk_add_f32 v[60:61], v[60:61], v[108:109]
v_pk_add_f32 v[62:63], v[62:63], v[110:111]
v_cvt_pk_bf16_f32 v194, v60, v61
v_cvt_pk_bf16_f32 v195, v62, v63
v_pk_add_f32 v[72:73], v[72:73], v[120:121]
v_pk_add_f32 v[74:75], v[74:75], v[122:123]
v_cvt_pk_bf16_f32 v196, v72, v73
v_cvt_pk_bf16_f32 v197, v74, v75
v_pk_add_f32 v[84:85], v[84:85], v[132:133]
v_pk_add_f32 v[86:87], v[86:87], v[134:135]
v_cvt_pk_bf16_f32 v198, v84, v85
v_cvt_pk_bf16_f32 v199, v86, v87
v_permlane32_swap_b32 v192, v194
v_permlane32_swap_b32 v193, v195
v_permlane32_swap_b32 v196, v198
v_permlane32_swap_b32 v197, v199
v_permlane16_swap_b32 v192, v194
v_permlane16_swap_b32 v193, v195
v_permlane16_swap_b32 v196, v198
v_permlane16_swap_b32 v197, v199
s_mov_b32 s38, 0
buffer_store_dwordx4 v[192:195], v243, s[40:43], s38 offen offset:0 sc0 sc1
buffer_store_dwordx4 v[196:199], v243, s[40:43], s38 offen offset:64 sc0 sc1
v_pk_add_f32 v[52:53], v[52:53], v[100:101]
v_pk_add_f32 v[54:55], v[54:55], v[102:103]
v_cvt_pk_bf16_f32 v200, v52, v53
v_cvt_pk_bf16_f32 v201, v54, v55
v_pk_add_f32 v[64:65], v[64:65], v[112:113]
v_pk_add_f32 v[66:67], v[66:67], v[114:115]
v_cvt_pk_bf16_f32 v202, v64, v65
v_cvt_pk_bf16_f32 v203, v66, v67
v_pk_add_f32 v[76:77], v[76:77], v[124:125]
v_pk_add_f32 v[78:79], v[78:79], v[126:127]
v_cvt_pk_bf16_f32 v204, v76, v77
v_cvt_pk_bf16_f32 v205, v78, v79
v_pk_add_f32 v[88:89], v[88:89], v[136:137]
v_pk_add_f32 v[90:91], v[90:91], v[138:139]
v_cvt_pk_bf16_f32 v206, v88, v89
v_cvt_pk_bf16_f32 v207, v90, v91
v_permlane32_swap_b32 v200, v202
v_permlane32_swap_b32 v201, v203
v_permlane32_swap_b32 v204, v206
v_permlane32_swap_b32 v205, v207
v_permlane16_swap_b32 v200, v202
v_permlane16_swap_b32 v201, v203
v_permlane16_swap_b32 v204, v206
v_permlane16_swap_b32 v205, v207
s_mov_b32 s38, 32768
buffer_store_dwordx4 v[200:203], v243, s[40:43], s38 offen offset:0 sc0 sc1
buffer_store_dwordx4 v[204:207], v243, s[40:43], s38 offen offset:64 sc0 sc1
v_pk_add_f32 v[56:57], v[56:57], v[104:105]
v_pk_add_f32 v[58:59], v[58:59], v[106:107]
v_cvt_pk_bf16_f32 v208, v56, v57
v_cvt_pk_bf16_f32 v209, v58, v59
v_pk_add_f32 v[68:69], v[68:69], v[116:117]
v_pk_add_f32 v[70:71], v[70:71], v[118:119]
v_cvt_pk_bf16_f32 v210, v68, v69
v_cvt_pk_bf16_f32 v211, v70, v71
v_pk_add_f32 v[80:81], v[80:81], v[128:129]
v_pk_add_f32 v[82:83], v[82:83], v[130:131]
v_cvt_pk_bf16_f32 v212, v80, v81
v_cvt_pk_bf16_f32 v213, v82, v83
v_pk_add_f32 v[92:93], v[92:93], v[140:141]
v_pk_add_f32 v[94:95], v[94:95], v[142:143]
v_cvt_pk_bf16_f32 v214, v92, v93
v_cvt_pk_bf16_f32 v215, v94, v95
v_permlane32_swap_b32 v208, v210
v_permlane32_swap_b32 v209, v211
v_permlane32_swap_b32 v212, v214
v_permlane32_swap_b32 v213, v215
v_permlane16_swap_b32 v208, v210
v_permlane16_swap_b32 v209, v211
v_permlane16_swap_b32 v212, v214
v_permlane16_swap_b32 v213, v215
s_mov_b32 s38, 65536
buffer_store_dwordx4 v[208:211], v243, s[40:43], s38 offen offset:0 sc0 sc1
buffer_store_dwordx4 v[212:215], v243, s[40:43], s38 offen offset:64 sc0 sc1
K2_FIN:
K2_END:

s_endpgm
.section .rodata,"a"
.p2align 6
.amdhsa_kernel oproj_kernel
  .amdhsa_next_free_vgpr 256
  .amdhsa_next_free_sgpr 96
  .amdhsa_accum_offset 256
  .amdhsa_group_segment_fixed_size 0
  .amdhsa_kernarg_size 104
  .amdhsa_user_sgpr_count 2
  .amdhsa_user_sgpr_kernarg_segment_ptr 1
  .amdhsa_system_sgpr_workgroup_id_x 1
.end_amdhsa_kernel
.text
.globl reduce_kernel
.p2align 8
.type reduce_kernel,@function
reduce_kernel:
s_cmp_ge_u32 s2, 768
s_cbranch_scc1 K3_END
s_load_dwordx2 s[20:21], s[0:1], 80
s_load_dwordx2 s[24:25], s[0:1], 96
s_mul_i32 s3, s2, 4096
v_lshlrev_b32 v1, 4, v0
v_add_u32 v1, s3, v1
s_waitcnt lgkmcnt(0)
s_add_u32 s8, s24, 33554432
s_addc_u32 s9, s25, 0
s_mov_b32 s10, 12582912
s_mov_b32 s11, 0x20000
s_mov_b32 s12, s20
s_mov_b32 s13, s21
s_mov_b32 s14, 3145728
s_mov_b32 s15, 0x20000
s_mov_b32 s30, 0
buffer_load_dwordx4 v[4:7], v1, s[8:11], s30 offen
s_mov_b32 s31, 3145728
buffer_load_dwordx4 v[8:11], v1, s[8:11], s31 offen
s_mov_b32 s32, 6291456
buffer_load_dwordx4 v[12:15], v1, s[8:11], s32 offen
s_mov_b32 s33, 9437184
buffer_load_dwordx4 v[16:19], v1, s[8:11], s33 offen
s_waitcnt vmcnt(3)
v_lshlrev_b32 v24, 16, v4
v_and_b32 v25, 0xffff0000, v4
v_lshlrev_b32 v26, 16, v5
v_and_b32 v27, 0xffff0000, v5
v_lshlrev_b32 v28, 16, v6
v_and_b32 v29, 0xffff0000, v6
v_lshlrev_b32 v30, 16, v7
v_and_b32 v31, 0xffff0000, v7
s_waitcnt vmcnt(2)
v_lshlrev_b32 v20, 16, v8
v_and_b32 v21, 0xffff0000, v8
v_add_f32 v24, v24, v20
v_add_f32 v25, v25, v21
v_lshlrev_b32 v20, 16, v9
v_and_b32 v21, 0xffff0000, v9
v_add_f32 v26, v26, v20
v_add_f32 v27, v27, v21
v_lshlrev_b32 v20, 16, v10
v_and_b32 v21, 0xffff0000, v10
v_add_f32 v28, v28, v20
v_add_f32 v29, v29, v21
v_lshlrev_b32 v20, 16, v11
v_and_b32 v21, 0xffff0000, v11
v_add_f32 v30, v30, v20
v_add_f32 v31, v31, v21
s_waitcnt vmcnt(1)
v_lshlrev_b32 v20, 16, v12
v_and_b32 v21, 0xffff0000, v12
v_add_f32 v24, v24, v20
v_add_f32 v25, v25, v21
v_lshlrev_b32 v20, 16, v13
v_and_b32 v21, 0xffff0000, v13
v_add_f32 v26, v26, v20
v_add_f32 v27, v27, v21
v_lshlrev_b32 v20, 16, v14
v_and_b32 v21, 0xffff0000, v14
v_add_f32 v28, v28, v20
v_add_f32 v29, v29, v21
v_lshlrev_b32 v20, 16, v15
v_and_b32 v21, 0xffff0000, v15
v_add_f32 v30, v30, v20
v_add_f32 v31, v31, v21
s_waitcnt vmcnt(0)
v_lshlrev_b32 v20, 16, v16
v_and_b32 v21, 0xffff0000, v16
v_add_f32 v24, v24, v20
v_add_f32 v25, v25, v21
v_lshlrev_b32 v20, 16, v17
v_and_b32 v21, 0xffff0000, v17
v_add_f32 v26, v26, v20
v_add_f32 v27, v27, v21
v_lshlrev_b32 v20, 16, v18
v_and_b32 v21, 0xffff0000, v18
v_add_f32 v28, v28, v20
v_add_f32 v29, v29, v21
v_lshlrev_b32 v20, 16, v19
v_and_b32 v21, 0xffff0000, v19
v_add_f32 v30, v30, v20
v_add_f32 v31, v31, v21
v_cvt_pk_bf16_f32 v32, v24, v25
v_cvt_pk_bf16_f32 v33, v26, v27
v_cvt_pk_bf16_f32 v34, v28, v29
v_cvt_pk_bf16_f32 v35, v30, v31
buffer_store_dwordx4 v[32:35], v1, s[12:15], 0 offen
s_nop 0
K3_END:

s_endpgm
.section .rodata,"a"
.p2align 6
.amdhsa_kernel reduce_kernel
  .amdhsa_next_free_vgpr 64
  .amdhsa_next_free_sgpr 96
  .amdhsa_accum_offset 64
  .amdhsa_group_segment_fixed_size 0
  .amdhsa_kernarg_size 104
  .amdhsa_user_sgpr_count 2
  .amdhsa_user_sgpr_kernarg_segment_ptr 1
  .amdhsa_system_sgpr_workgroup_id_x 1
.end_amdhsa_kernel
```
